```python
import torch

def _softmax(x, axis=-1):
    return torch.softmax(x, dim=axis)
def _gelu(x):
    return torch.nn.functional.gelu(x, approximate="tanh")
def _silu(x):
    return torch.nn.functional.silu(x)
def _sigmoid(x):
    return torch.sigmoid(x)
def _layernorm(x, axis=-1, eps=1e-5):
    m = x.mean(dim=axis, keepdim=True)
    v = x.var(dim=axis, keepdim=True, unbiased=False)
    return (x - m) / torch.sqrt(v + eps)
def _scatter_add(tgt, idx, src, axis=0):
    return tgt.clone().index_add_(axis, idx, src)
def _segment_sum(src, seg, n):
    out = torch.zeros((n,) + src.shape[1:], dtype=src.dtype)
    return out.index_add_(0, seg, src)
def _pad(x, pw):
    flat = tuple(v for pair in reversed(pw) for v in pair)
    return torch.nn.functional.pad(x, flat)

kernel_name = 'parallel_sum__gqa_block_cached__glu_gated_geglu__decode'

def setup_inputs():

    _w = (lambda a: (lambda t: t.to(torch.bfloat16) if t.is_floating_point() else t)(torch.as_tensor(a)))
    def _A_setup():
        B, Sq, D = 8, 1, 1024
        Hq, Hkv, Sk, Dh = 32, 4, 8192, 128
        assert Hq % Hkv == 0, (Hq, Hkv)
        return {
            "x": _w((lambda *s: torch.randn(*s, dtype=torch.bfloat16) * 0.05)(B, Sq, D)),
            "k_cache": _w((lambda *s: torch.randn(*s, dtype=torch.bfloat16) * 1.6)(B, Hkv, Sk, Dh)),
            "v_cache": _w((lambda *s: torch.randn(*s, dtype=torch.bfloat16) * 0.8)(B, Hkv, Sk, Dh)),
            "wq": _w((lambda *s: torch.randn(*s, dtype=torch.bfloat16) * 1.6)(D, Hq * Dh) * (D ** -0.5)),
            "wo": _w((lambda *s: torch.randn(*s, dtype=torch.bfloat16) * 0.8)(Hq * Dh, D) * ((Hq * Dh) ** -0.5)),
        }
    _A_in = _A_setup()

    def _B_setup():
        B, S, Dm, Df = 8, 1, 1024, 3584
        return {
            "x": _w((lambda *s: torch.randn(*s, dtype=torch.bfloat16) * 0.05)(B, S, Dm)),
            "w_gate": _w((lambda *s: torch.randn(*s, dtype=torch.bfloat16) * 0.4)(Dm, Df) * (Dm ** -0.5)),
            "w_up": _w((lambda *s: torch.randn(*s, dtype=torch.bfloat16) * 0.4)(Dm, Df) * (Dm ** -0.5)),
            "w_down": _w((lambda *s: torch.randn(*s, dtype=torch.bfloat16) * 0.4)(Df, Dm) * (Df ** -0.5)),
        }
    _B_in = _B_setup()

    return {
        "A_x": _A_in["x"],
        "A_k_cache": _A_in["k_cache"],
        "A_v_cache": _A_in["v_cache"],
        "A_wq": _A_in["wq"],
        "A_wo": _A_in["wo"],
        "B_x": _B_in["x"],
        "B_w_gate": _B_in["w_gate"],
        "B_w_up": _B_in["w_up"],
        "B_w_down": _B_in["w_down"],
    }

def reference(A_x, A_k_cache, A_v_cache, A_wq, A_wo, B_x, B_w_gate, B_w_up, B_w_down):
    def _A_ref(x, k_cache, v_cache, wq, wo):
        B, Sq, D = x.shape
        Hq, Dh = 32, 128
        Hkv = k_cache.shape[1]
        rep = Hq // Hkv
        q = (lambda x, *d: x.permute(*d))((x @ wq).reshape(B, Sq, Hq, Dh), 0, 2, 1, 3)
        k = (lambda x, n, axis: torch.repeat_interleave(x, n, dim=axis))(k_cache, rep, axis=1)
        v = (lambda x, n, axis: torch.repeat_interleave(x, n, dim=axis))(v_cache, rep, axis=1)
        scores = torch.einsum("bhqd,bhkd->bhqk", q, k) * (Dh ** -0.5)
        p = _softmax(scores, axis=-1)
        o = torch.einsum("bhqk,bhkd->bhqd", p, v)
        return (lambda x, *d: x.permute(*d))(o, 0, 2, 1, 3).reshape(B, Sq, Hq * Dh) @ wo

    def _B_ref(x, w_gate, w_up, w_down):
        g = torch.einsum("bsd,df->bsf", x, w_gate)
        u = torch.einsum("bsd,df->bsf", x, w_up)
        h = _gelu(g) * u
        return torch.einsum("bsf,fd->bsd", h, w_down)

    x = A_x
    xn = _layernorm(x, axis=-1)
    return x + _A_ref(xn, A_k_cache, A_v_cache, A_wq, A_wo) + _B_ref(xn, B_w_gate, B_w_up, B_w_down)
```

```asm
; @launch grid=(256,1,1) block=(512,1,1) lds=58880
.amdgcn_target "amdgcn-amd-amdhsa--gfx950"
.text
.globl parallel_sum__gqa_block_cached__glu_gated_geglu__decode_kernel
.p2align 12
.type parallel_sum__gqa_block_cached__glu_gated_geglu__decode_kernel,@function
parallel_sum__gqa_block_cached__glu_gated_geglu__decode_kernel:
    s_cmp_ge_u32 s2, 256
    s_cbranch_scc1 L_end
    s_load_dwordx16 s[4:19], s[0:1], 0
    s_load_dwordx8 s[20:27], s[0:1], 64
    v_lshrrev_b32 v1, 6, v0
    v_lshlrev_b32 v2, 2, v0
    v_and_b32 v0, 63, v0
    v_mov_b32 v9, 0
    ds_write_b32 v2, v9 offset:256
    v_readfirstlane_b32 s3, v1
    v_lshlrev_b32 v3, 2, v0
    s_lshr_b32 s56, s2, 5
    s_bfe_u32 s57, s2, 0x10002
    s_lshl1_add_u32 s56, s56, s57
    s_bfe_u32 s57, s2, 0x10003
    s_lshl1_add_u32 s56, s56, s57
    s_bfe_u32 s57, s2, 0x10001
    s_lshl1_add_u32 s56, s56, s57
    s_bfe_u32 s57, s2, 0x10000
    s_lshl1_add_u32 s56, s56, s57
    s_bfe_u32 s57, s2, 0x10004
    s_lshl1_add_u32 s56, s56, s57
    s_mov_b32 s2, s56
    s_lshr_b32 s56, s2, 3
    s_and_b32 s57, s2, 7
    s_mov_b32 s62, 20000
    s_mov_b32 s58, 0x05040100
    s_mov_b32 s59, 0x07060302
    s_add_u32 s60, s56, s57
    s_and_b32 s60, s60, 7
    s_bfe_u32 s61, s56, 0x10002
    s_add_u32 s63, s61, 3
    s_min_u32 s65, s60, s63
    s_mul_i32 s65, s65, 0
    s_mul_i32 s66, s60, 48
    s_sub_u32 s65, s66, s65
    s_lshl_b32 s65, s60, 2
    s_movk_i32 s94, 384
    s_cmp_eq_u32 s61, 0
    s_cselect_b32 s94, 384, s94
    s_movk_i32 s95, 48
    s_lshl_b32 s66, s61, 3
    s_add_u32 s66, s66, s60
    s_cmp_eq_u32 s66, 7
    s_cselect_b32 s89, 0, 1
    s_cselect_b32 s95, 48, s95
    s_cmp_lt_u32 s60, s63
    s_cselect_b32 s89, 2, s89
    s_cselect_b32 s95, 48, s95
    s_lshr_b32 s64, s56, 3
    s_and_b32 s63, s56, 3
    s_lshl_b32 s67, s64, 2
    s_add_u32 s67, s67, s63
    s_lshl_b32 s68, s67, 1
    s_sub_u32 s68, s68, 1
    s_lshl_b32 s69, s67, 2
    s_add_u32 s69, s69, 32
    s_lshl_b32 s70, s64, 2
    s_sub_u32 s70, s70, 3
    s_mul_i32 s71, s64, 3
    s_add_u32 s71, s71, 11
    s_cmp_eq_u32 s61, 0
    s_cselect_b32 s68, s68, s69
    s_cselect_b32 s70, s70, s71
    s_cmp_eq_u32 s89, 2
    s_cselect_b32 s68, s68, s70
    s_cselect_b32 s64, s67, s64
    s_cselect_b32 s63, 0, s63
    s_add_u32 s68, s68, s60
    s_add_u32 s69, s67, 82
    s_cmp_eq_u32 s66, 0
    s_cselect_b32 s68, s69, s68
    s_lshr_b32 s69, s68, 1
    s_add_u32 s70, s69, 4
    s_mul_i32 s70, s70, 37
    s_lshr_b32 s70, s70, 8
    s_add_u32 s69, s69, s70
    s_lshr_b32 s70, s64, 1
    s_lshl_b32 s70, s70, 3
    s_add_u32 s70, s70, 3
    s_cmp_lt_u32 s67, 14
    s_cselect_b32 s71, 0, 12
    s_cmp_eq_u32 s66, s71
    s_cselect_b32 s71, 12, s66
    s_cmp_eq_u32 s71, 12
    s_cselect_b32 s68, s64, s68
    s_cselect_b32 s69, s70, s69
    s_and_b32 s64, s68, 1
    s_lshl_b32 s63, s63, 4
    s_add_u32 s66, s69, s63
    s_lshl_b32 s60, s64, 17
    s_lshl_b32 s61, s66, 8
    s_add_u32 s60, s60, s61
    s_lshl_b32 s93, s64, 16
    s_lshl_b32 s61, s66, 10
    s_add_u32 s93, s93, s61
    s_add_u32 s93, s93, 524288
    s_cmp_eq_u32 s89, 2
    s_cselect_b32 s93, s93, s60
    v_and_b32 v5, 15, v0
    v_lshrrev_b32 v6, 4, v0
    v_mov_b32 v7, 0
    s_cmp_lg_u32 s3, 4
    s_cbranch_scc1 L_noz
    ds_write_b32 v3, v9
    v_mov_b32 v8, 15
    ds_write_b32 v7, v8 offset:20
L_noz:
    s_waitcnt lgkmcnt(0)
    s_barrier
    s_mov_b32 s36, s26
    s_mov_b32 s37, s27
    s_mov_b32 s38, 268435456
    s_mov_b32 s39, 0x00020000
    s_cmp_lt_u32 s3, 4
    s_cbranch_scc1 L_G
    s_setprio 3
    v_mov_b32 v40, -1
    v_mov_b32 v41, -1
    v_mov_b32 v42, -1
    v_mov_b32 v43, -1
    s_sub_u32 s64, s3, 4
    v_lshlrev_b32 v2, 14, v6
    v_lshl_add_u32 v2, v5, 4, v2
    v_lshlrev_b32 v1, 4, v0
    v_mov_b32 v22, 1
    v_mov_b32 v21, 0
    v_mov_b32 v20, 1
    s_lshl_b32 s72, s2, 8
    s_add_u32 s72, s72, 1638400
    s_cmp_lg_u32 s64, 0
    s_cbranch_scc1 L_clr12
    s_mov_b64 exec, 1
    buffer_store_dwordx2 v[40:41], v21, s[36:39], s72 offen offset:0 sc0 sc1
    buffer_store_dword v21, v21, s[36:39], s72 offen offset:128 sc1
    s_mov_b64 exec, -1
    s_cmp_eq_u32 s89, 0
    s_cbranch_scc1 L_clrd
    s_cmp_eq_u32 s89, 2
    s_cbranch_scc1 L_clrf
    s_add_u32 s71, s93, 65536
    buffer_store_dwordx4 v[40:43], v2, s[36:39], s93 offen offset:0 sc0 sc1
    buffer_store_dwordx4 v[40:43], v2, s[36:39], s71 offen offset:0 sc0 sc1
    s_branch L_clrd
L_clrf:
    buffer_store_dwordx4 v[40:43], v1, s[36:39], s93 offen offset:0 sc0 sc1
    s_branch L_clrd
L_clr12:
    s_lshl_b32 s60, s2, 12
    s_lshl_b32 s61, s64, 10
    s_add_u32 s60, s60, s61
    s_add_u32 s70, s60, 2097152
    s_add_u32 s71, s60, 3145728
    buffer_store_dwordx4 v[40:43], v1, s[36:39], s70 offen offset:0 sc0 sc1
    buffer_store_dwordx4 v[40:43], v1, s[36:39], s71 offen offset:0 sc0 sc1
    s_cmp_eq_u32 s64, 3
    s_cbranch_scc1 L_clrd
    s_cmp_eq_u32 s64, 1
    s_cselect_b32 s70, s70, s71
    s_sub_u32 s70, s70, s61
    buffer_store_dwordx4 v[40:43], v1, s[36:39], s70 offen offset:0 sc0 sc1
L_clrd:
    s_cmp_eq_u32 s64, 0
    s_cbranch_scc1 L_blk2
    s_cmp_eq_u32 s64, 1
    s_cbranch_scc1 L_blk9
    s_cmp_eq_u32 s64, 2
    s_cbranch_scc1 L_blk1
    s_cmp_eq_u32 s64, 3
    s_cbranch_scc1 L_blk3
L_blkret:
    s_branch L_A2
L_G:
    s_bfe_u32 s56, s2, 0x20003
    s_xor_b32 s56, s56, 2
    s_mov_b32 s57, 0
    s_bfe_u32 s60, s2, 0x10002
    s_lshl1_add_u32 s56, s56, s60
    s_bfe_u32 s60, s2, 0x10007
    s_lshl1_add_u32 s56, s56, s60
    s_bfe_u32 s60, s2, 0x10000
    s_lshl1_add_u32 s56, s56, s60
    s_bfe_u32 s60, s2, 0x10001
    s_lshl1_add_u32 s57, s57, s60
    s_bfe_u32 s60, s2, 0x10006
    s_lshl1_add_u32 s57, s57, s60
    s_bfe_u32 s60, s2, 0x10005
    s_lshl1_add_u32 s57, s57, s60
    s_mov_b32 s32, s4
    s_mov_b32 s33, s5
    s_mov_b32 s34, 16384
    s_mov_b32 s35, 0x00020000
    v_lshlrev_b32 v1, 5, v0
    s_lshl_b32 s60, s3, 12
    buffer_load_dwordx4 v[10:13], v1, s[32:35], s60 offen offset:0
    buffer_load_dwordx4 v[14:17], v1, s[32:35], s60 offen offset:16
    buffer_load_dwordx4 v[18:21], v1, s[32:35], s60 offen offset:2048
    buffer_load_dwordx4 v[22:25], v1, s[32:35], s60 offen offset:2064
    s_mov_b32 s28, s10
    s_mov_b32 s29, s11
    s_mov_b32 s30, 8388608
    s_mov_b32 s31, 0x00020000
    s_movk_i32 s69, 0x2000
    s_lshl_b32 s67, s64, 2
    s_add_u32 s67, s67, s3
    s_lshl_b32 s67, s67, 7
    s_cmp_lg_u32 s89, 2
    s_cbranch_scc1 L_notf
    s_mov_b32 s28, s16
    s_mov_b32 s29, s17
    s_mov_b32 s30, 7340032
    s_mov_b32 s31, 0x00020000
    s_movk_i32 s69, 0x1c00
    s_lshl_b32 s67, s3, 8
    s_cmp_eq_u32 s64, 0
    s_cbranch_scc1 L_notf
    s_mov_b32 s28, s18
    s_mov_b32 s29, s19
    s_mov_b32 s30, 7340032
    s_mov_b32 s31, 0x00020000
L_notf:
    s_lshl_b32 s61, s66, 7
    s_mul_i32 s68, s67, s69
    s_add_u32 s68, s68, s61
    s_mul_i32 s70, s69, 57
    s_cmp_eq_u32 s89, 0
    s_cselect_b32 s68, 2146435072, s68
    v_lshrrev_b32 v3, 3, v0
    v_lshlrev_b32 v3, 3, v3
    v_mul_u32_u24 v3, s69, v3
    v_and_b32 v2, 7, v0
    v_lshl_add_u32 v39, v2, 4, v3
    buffer_load_dwordx4 v[40:43], v39, s[28:31], s68 offen nt
    s_add_u32 s68, s68, s69
    buffer_load_dwordx4 v[44:47], v39, s[28:31], s68 offen nt
    s_add_u32 s68, s68, s69
    buffer_load_dwordx4 v[48:51], v39, s[28:31], s68 offen nt
    s_add_u32 s68, s68, s69
    buffer_load_dwordx4 v[52:55], v39, s[28:31], s68 offen nt
    s_add_u32 s68, s68, s69
    buffer_load_dwordx4 v[56:59], v39, s[28:31], s68 offen nt
    s_add_u32 s68, s68, s69
    buffer_load_dwordx4 v[60:63], v39, s[28:31], s68 offen nt
    s_add_u32 s68, s68, s69
    buffer_load_dwordx4 v[64:67], v39, s[28:31], s68 offen nt
    s_add_u32 s68, s68, s69
    buffer_load_dwordx4 v[68:71], v39, s[28:31], s68 offen nt
    s_add_u32 s68, s68, s70
    buffer_load_dwordx4 v[72:75], v39, s[28:31], s68 offen nt
    s_add_u32 s68, s68, s69
    buffer_load_dwordx4 v[76:79], v39, s[28:31], s68 offen nt
    s_add_u32 s68, s68, s69
    buffer_load_dwordx4 v[80:83], v39, s[28:31], s68 offen nt
    s_add_u32 s68, s68, s69
    buffer_load_dwordx4 v[84:87], v39, s[28:31], s68 offen nt
    s_add_u32 s68, s68, s69
    buffer_load_dwordx4 v[88:91], v39, s[28:31], s68 offen nt
    s_add_u32 s68, s68, s69
    buffer_load_dwordx4 v[92:95], v39, s[28:31], s68 offen nt
    s_add_u32 s68, s68, s69
    buffer_load_dwordx4 v[96:99], v39, s[28:31], s68 offen nt
    s_add_u32 s68, s68, s69
    buffer_load_dwordx4 v[100:103], v39, s[28:31], s68 offen nt
    s_add_u32 s68, s68, s70
    s_cmp_lg_u32 s89, 2
    s_cbranch_scc1 L_wa3
    buffer_load_dwordx4 v[136:139], v39, s[28:31], s68 offen nt
    s_add_u32 s68, s68, s69
    buffer_load_dwordx4 v[140:143], v39, s[28:31], s68 offen nt
    s_add_u32 s68, s68, s69
    buffer_load_dwordx4 v[144:147], v39, s[28:31], s68 offen nt
    s_add_u32 s68, s68, s69
    buffer_load_dwordx4 v[148:151], v39, s[28:31], s68 offen nt
    s_add_u32 s68, s68, s69
    buffer_load_dwordx4 v[152:155], v39, s[28:31], s68 offen nt
    s_add_u32 s68, s68, s69
    buffer_load_dwordx4 v[156:159], v39, s[28:31], s68 offen nt
    s_add_u32 s68, s68, s69
    buffer_load_dwordx4 v[160:163], v39, s[28:31], s68 offen nt
    s_add_u32 s68, s68, s69
    buffer_load_dwordx4 v[164:167], v39, s[28:31], s68 offen nt
    s_add_u32 s68, s68, s70
    buffer_load_dwordx4 v[200:203], v39, s[28:31], s68 offen nt
    s_add_u32 s68, s68, s69
    buffer_load_dwordx4 v[204:207], v39, s[28:31], s68 offen nt
    s_add_u32 s68, s68, s69
    buffer_load_dwordx4 v[208:211], v39, s[28:31], s68 offen nt
    s_add_u32 s68, s68, s69
    buffer_load_dwordx4 v[212:215], v39, s[28:31], s68 offen nt
    s_add_u32 s68, s68, s69
    buffer_load_dwordx4 v[216:219], v39, s[28:31], s68 offen nt
    s_add_u32 s68, s68, s69
    buffer_load_dwordx4 v[220:223], v39, s[28:31], s68 offen nt
    s_add_u32 s68, s68, s69
    buffer_load_dwordx4 v[224:227], v39, s[28:31], s68 offen nt
    s_add_u32 s68, s68, s69
    buffer_load_dwordx4 v[228:231], v39, s[28:31], s68 offen nt
    s_add_u32 s68, s68, s70
    s_cmp_eq_u32 s3, 3
    s_cselect_b32 s77, 0, -1
    s_mov_b32 s76, -1
    s_mov_b32 s44, s20
    s_mov_b32 s45, s21
    s_mov_b32 s46, 7340032
    s_mov_b32 s47, 0x00020000
    v_mov_b32 v168, 0
    v_mov_b32 v169, 0
    v_mov_b32 v170, 0
    v_mov_b32 v171, 0
    v_mov_b32 v172, 0
    v_mov_b32 v173, 0
    v_mov_b32 v174, 0
    v_mov_b32 v175, 0
    v_mov_b32 v176, 0
    v_mov_b32 v177, 0
    v_mov_b32 v178, 0
    v_mov_b32 v179, 0
    v_mov_b32 v180, 0
    v_mov_b32 v181, 0
    v_mov_b32 v182, 0
    v_mov_b32 v183, 0
    v_mov_b32 v184, 0
    v_mov_b32 v185, 0
    v_mov_b32 v186, 0
    v_mov_b32 v187, 0
    v_mov_b32 v188, 0
    v_mov_b32 v189, 0
    v_mov_b32 v190, 0
    v_mov_b32 v191, 0
    v_mov_b32 v192, 0
    v_mov_b32 v193, 0
    v_mov_b32 v194, 0
    v_mov_b32 v195, 0
    v_mov_b32 v196, 0
    v_mov_b32 v197, 0
    v_mov_b32 v198, 0
    v_mov_b32 v199, 0
    v_lshlrev_b32 v232, 14, v6
    v_lshl_add_u32 v232, v5, 4, v232
    s_mul_i32 s60, s56, 112
    s_lshl_b32 s61, s3, 5
    s_add_u32 s60, s60, s61
    s_lshl_b32 s60, s60, 11
    s_lshl_b32 s61, s57, 8
    s_add_u32 s52, s60, s61
    s_mov_b64 exec, s[76:77]
    buffer_load_dwordx4 v[168:171], v232, s[44:47], s52 offen offset:0 nt
    buffer_load_dwordx4 v[172:175], v232, s[44:47], s52 offen offset:2048 nt
    s_add_u32 s52, s52, 4096
    buffer_load_dwordx4 v[176:179], v232, s[44:47], s52 offen offset:0 nt
    buffer_load_dwordx4 v[180:183], v232, s[44:47], s52 offen offset:2048 nt
    s_add_u32 s52, s52, 4096
    buffer_load_dwordx4 v[184:187], v232, s[44:47], s52 offen offset:0 nt
    buffer_load_dwordx4 v[188:191], v232, s[44:47], s52 offen offset:2048 nt
    s_add_u32 s52, s52, 4096
    buffer_load_dwordx4 v[192:195], v232, s[44:47], s52 offen offset:0 nt
    buffer_load_dwordx4 v[196:199], v232, s[44:47], s52 offen offset:2048 nt
    s_add_u32 s52, s52, 4096
    s_mov_b64 exec, -1
L_wa3:
    s_waitcnt lgkmcnt(0)
    s_mov_b64 exec, 1
    v_mov_b32 v8, 1
    ds_add_u32 v7, v8 offset:32
    s_mov_b64 exec, -1
    s_branch L_G2
L_A2:
    s_mov_b32 s52, s24
    s_mov_b32 s53, s25
    s_mov_b32 s54, 256
    s_mov_b32 s55, 0x00020000
    s_and_b32 s73, s56, 3
    s_lshl_b32 s73, s73, 6
    s_lshl_b32 s63, s56, 21
    s_add_u32 s28, s6, s63
    s_addc_u32 s29, s7, 0
    s_mov_b32 s30, 0x200000
    s_mov_b32 s31, 0x00020000
    s_add_u32 s32, s8, s63
    s_addc_u32 s33, s9, 0
    s_mov_b32 s34, 0x200000
    s_mov_b32 s35, 0x00020000
    v_lshlrev_b32 v1, 4, v6
    v_lshlrev_b32 v2, 4, v5
    v_bfe_u32 v3, v5, 0, 1
    v_lshl_add_u32 v1, v3, 9, v1
    v_bfe_u32 v3, v5, 1, 1
    v_lshl_add_u32 v1, v3, 11, v1
    v_bfe_u32 v3, v5, 2, 1
    v_lshl_add_u32 v1, v3, 16, v1
    v_bfe_u32 v3, v5, 3, 1
    v_lshl_add_u32 v1, v3, 17, v1
    v_bfe_u32 v3, v6, 0, 1
    v_lshl_add_u32 v2, v3, 16, v2
    v_bfe_u32 v3, v6, 1, 1
    v_lshl_add_u32 v2, v3, 17, v2
    s_mov_b32 s66, 0
    s_mov_b32 s82, 0
    s_mov_b32 s83, 0
    s_mul_i32 s81, s56, 144
    s_cmp_lg_u32 s64, 0
    s_cbranch_scc1 L_Astream
    s_waitcnt vmcnt(0)
    s_mov_b64 exec, 1
    ds_add_u32 v21, v22 offset:28
Llw_1:
    ds_read_b32 v8, v7 offset:40
    s_waitcnt lgkmcnt(0)
    v_readfirstlane_b32 s60, v8
    s_cmp_ge_u32 s60, 3
    s_cbranch_scc1 Llwd_2
    s_branch Llw_1
Llwd_2:
    buffer_atomic_add v20, v21, s[52:55], s73 offen sc0
    s_mov_b64 exec, -1
    s_lshr_b32 s60, s56, 2
    s_lshl_b32 s60, s60, 14
    s_and_b32 s61, s56, 3
    s_lshl_b32 s61, s61, 12
    s_add_u32 s76, s60, s61
    s_add_u32 s77, s76, 131072
    v_lshlrev_b32 v10, 4, v0
    v_lshrrev_b32 v11, 5, v0
    v_mul_u32_u24 v11, 288, v11
    v_and_b32 v12, 31, v0
    v_lshl_add_u32 v11, v12, 3, v11
    v_lshrrev_b32 v19, 3, v0
    v_and_b32 v18, 7, v0
    v_lshl_add_u32 v19, v19, 5, v18
    v_lshlrev_b32 v19, 8, v19
    s_lshl_b32 s75, s73, 5
    s_add_u32 s75, s75, 1638400
    v_mov_b32 v12, 0
    v_mov_b32 v13, 0
    v_mov_b32 v14, 0
    v_mov_b32 v15, 0
    s_mov_b32 s61, 0
    s_waitcnt vmcnt(0)
    v_readfirstlane_b32 s60, v20
    s_cmp_lg_u32 s60, 63
    s_cbranch_scc1 L_mbp
    buffer_store_dword v22, v19, s[36:39], s75 offen sc1
    v_mov_b32 v18, 1
    s_mov_b64 exec, 1
    buffer_atomic_add v18, v21, s[52:55], 0 offen offset:32 sc0
    s_mov_b64 exec, -1
    s_waitcnt vmcnt(0)
    v_readfirstlane_b32 s60, v18
    s_cmp_lg_u32 s60, 3
    s_cbranch_scc1 L_mbd
    v_lshlrev_b32 v19, 8, v0
    s_mov_b32 s60, 1638400
    buffer_store_dword v22, v19, s[36:39], s60 offen offset:4 sc1
    s_mov_b32 s60, 1654784
    buffer_store_dword v22, v19, s[36:39], s60 offen offset:4 sc1
    s_mov_b32 s60, 1671168
    buffer_store_dword v22, v19, s[36:39], s60 offen offset:4 sc1
    s_mov_b32 s60, 1687552
    buffer_store_dword v22, v19, s[36:39], s60 offen offset:4 sc1
    s_branch L_mbd
L_mbp:
    s_mov_b64 exec, 1
L_mbl:
    buffer_load_dword v12, v21, s[36:39], s72 offen sc1
    s_sleep 4
    s_waitcnt vmcnt(3)
    v_cmp_eq_u32 vcc, 1, v13
    s_nop 0
    s_cbranch_vccnz L_mbd
    buffer_load_dword v13, v21, s[36:39], s72 offen sc1
    s_sleep 4
    s_waitcnt vmcnt(3)
    v_cmp_eq_u32 vcc, 1, v14
    s_nop 0
    s_cbranch_vccnz L_mbd
    buffer_load_dword v14, v21, s[36:39], s72 offen sc1
    s_sleep 4
    s_waitcnt vmcnt(3)
    v_cmp_eq_u32 vcc, 1, v15
    s_nop 0
    s_cbranch_vccnz L_mbd
    buffer_load_dword v15, v21, s[36:39], s72 offen sc1
    s_sleep 4
    s_waitcnt vmcnt(3)
    v_cmp_eq_u32 vcc, 1, v12
    s_nop 0
    s_cbranch_vccnz L_mbd
    s_add_u32 s61, s61, 1
    s_cmp_lt_u32 s61, s62
    s_cbranch_scc1 L_mbl
L_mbd:
    s_mov_b64 exec, -1
    s_mov_b64 exec, -1
    s_mov_b32 s61, 0
    s_branch Lpollf_5
Lpoll_3:
    s_sleep 2
Lpollf_5:
    buffer_load_dwordx4 v[72:75], v10, s[36:39], s76 offen offset:0 sc1
    buffer_load_dwordx4 v[76:79], v10, s[36:39], s77 offen offset:0 sc1
    buffer_load_dwordx4 v[80:83], v10, s[36:39], s76 offen offset:1024 sc1
    buffer_load_dwordx4 v[84:87], v10, s[36:39], s77 offen offset:1024 sc1
    buffer_load_dwordx4 v[88:91], v10, s[36:39], s76 offen offset:2048 sc1
    buffer_load_dwordx4 v[92:95], v10, s[36:39], s77 offen offset:2048 sc1
    buffer_load_dwordx4 v[96:99], v10, s[36:39], s76 offen offset:3072 sc1
    buffer_load_dwordx4 v[100:103], v10, s[36:39], s77 offen offset:3072 sc1
    s_waitcnt vmcnt(0)
    v_max3_u32 v8, v72, v73, v74
    v_max3_u32 v8, v8, v75, v76
    v_max3_u32 v8, v8, v77, v78
    v_max3_u32 v8, v8, v79, v80
    v_max3_u32 v8, v8, v81, v82
    v_max3_u32 v8, v8, v83, v84
    v_max3_u32 v8, v8, v85, v86
    v_max3_u32 v8, v8, v87, v88
    v_max3_u32 v8, v8, v89, v90
    v_max3_u32 v8, v8, v91, v92
    v_max3_u32 v8, v8, v93, v94
    v_max3_u32 v8, v8, v95, v96
    v_max3_u32 v8, v8, v97, v98
    v_max3_u32 v8, v8, v99, v100
    v_max3_u32 v8, v8, v101, v102
    v_max_u32 v8, v8, v103
    v_cmp_eq_u32 vcc, -1, v8
    s_add_u32 s61, s61, 1
    s_cmp_ge_u32 s61, s62
    s_cbranch_scc1 Lpolld_4
    s_and_b64 exec, exec, vcc
    s_cbranch_scc1 Lpoll_3
Lpolld_4:
    s_mov_b64 exec, -1
    v_add_f32 v72, v72, v76
    v_add_f32 v73, v73, v77
    v_add_f32 v74, v74, v78
    v_add_f32 v75, v75, v79
    v_cvt_pk_bf16_f32 v72, v72, v73
    v_cvt_pk_bf16_f32 v73, v74, v75
    ds_write_b64 v11, v[72:73] offset:39424
    v_add_f32 v80, v80, v84
    v_add_f32 v81, v81, v85
    v_add_f32 v82, v82, v86
    v_add_f32 v83, v83, v87
    v_cvt_pk_bf16_f32 v80, v80, v81
    v_cvt_pk_bf16_f32 v81, v82, v83
    ds_write_b64 v11, v[80:81] offset:40000
    v_add_f32 v88, v88, v92
    v_add_f32 v89, v89, v93
    v_add_f32 v90, v90, v94
    v_add_f32 v91, v91, v95
    v_cvt_pk_bf16_f32 v88, v88, v89
    v_cvt_pk_bf16_f32 v89, v90, v91
    ds_write_b64 v11, v[88:89] offset:40576
    v_add_f32 v96, v96, v100
    v_add_f32 v97, v97, v101
    v_add_f32 v98, v98, v102
    v_add_f32 v99, v99, v103
    v_cvt_pk_bf16_f32 v96, v96, v97
    v_cvt_pk_bf16_f32 v97, v98, v99
    ds_write_b64 v11, v[96:97] offset:41152
L_ctld:
    s_waitcnt lgkmcnt(0)
    s_mov_b64 exec, 1
    v_mov_b32 v8, 1
    ds_add_u32 v7, v8 offset:8
    s_mov_b64 exec, -1
    s_setprio 0
    s_mov_b64 exec, 1
    ds_add_rtn_u32 v23, v21, v22 offset:20
    s_mov_b64 exec, -1
    s_movk_i32 s84, 0x7fff
    s_cmp_lg_u32 s66, 0
    s_cbranch_scc1 Lnoiss_6
    s_waitcnt lgkmcnt(0)
    v_readfirstlane_b32 s68, v23
    s_lshr_b32 s84, s68, 2
    s_lshl_b32 s84, s84, 5
    s_add_u32 s84, s84, s65
    s_and_b32 s80, s68, 3
    s_add_u32 s84, s84, s80
    s_cmp_lt_u32 s68, s95
    s_cbranch_scc1 Lgo_7
    s_sub_u32 s68, s68, s95
    s_lshl_b32 s68, s68, 2
    v_mov_b32 v19, s68
Lsp_8:
    ds_read_b32 v20, v19 offset:256
    s_waitcnt lgkmcnt(0)
    v_readfirstlane_b32 s84, v20
    s_cmp_eq_u32 s84, 0
    s_cbranch_scc1 Lsp_8
    s_lshr_b32 s66, s84, 9
    s_cbranch_scc1 Lnoiss_6
Lgo_7:
    s_add_u32 s68, s84, s81
    s_bfe_u32 s45, s68, 0x10000
    s_lshl_b32 s45, s45, 8
    s_bfe_u32 s80, s68, 0x10001
    s_lshl_b32 s80, s80, 10
    s_add_u32 s45, s45, s80
    s_bfe_u32 s80, s68, 0x10002
    s_lshl_b32 s80, s80, 12
    s_add_u32 s45, s45, s80
    s_bfe_u32 s80, s68, 0x10003
    s_lshl_b32 s80, s80, 14
    s_add_u32 s45, s45, s80
    s_bfe_u32 s80, s68, 0x10004
    s_lshl_b32 s80, s80, 19
    s_add_u32 s45, s45, s80
    s_bfe_u32 s80, s68, 0x10005
    s_lshl_b32 s80, s80, 15
    s_add_u32 s45, s45, s80
    s_bfe_u32 s80, s68, 0x10006
    s_lshl_b32 s80, s80, 18
    s_add_u32 s45, s45, s80
    s_bfe_u32 s80, s68, 0x10007
    s_lshl_b32 s80, s80, 13
    s_add_u32 s45, s45, s80
    s_bfe_u32 s80, s68, 0x10008
    s_lshl_b32 s80, s80, 20
    s_add_u32 s68, s45, s80
    buffer_load_dwordx4 v[72:75], v1, s[28:31], s68 offen offset:0 nt
    buffer_load_dwordx4 v[76:79], v1, s[28:31], s68 offen offset:64 nt
    buffer_load_dwordx4 v[80:83], v1, s[28:31], s68 offen offset:128 nt
    buffer_load_dwordx4 v[84:87], v1, s[28:31], s68 offen offset:192 nt
    buffer_load_dwordx4 v[88:91], v2, s[32:35], s68 offen offset:0 nt
    buffer_load_dwordx4 v[92:95], v2, s[32:35], s68 offen offset:512 nt
    buffer_load_dwordx4 v[96:99], v2, s[32:35], s68 offen offset:2048 nt
    buffer_load_dwordx4 v[100:103], v2, s[32:35], s68 offen offset:2560 nt
Lnoiss_6:
    s_mov_b64 exec, 1
    ds_add_rtn_u32 v23, v21, v22 offset:20
    s_mov_b64 exec, -1
    s_movk_i32 s85, 0x7fff
    s_cmp_lg_u32 s66, 0
    s_cbranch_scc1 Lnoiss_9
    s_waitcnt lgkmcnt(0)
    v_readfirstlane_b32 s68, v23
    s_lshr_b32 s85, s68, 2
    s_lshl_b32 s85, s85, 5
    s_add_u32 s85, s85, s65
    s_and_b32 s80, s68, 3
    s_add_u32 s85, s85, s80
    s_cmp_lt_u32 s68, s95
    s_cbranch_scc1 Lgo_10
    s_sub_u32 s68, s68, s95
    s_lshl_b32 s68, s68, 2
    v_mov_b32 v19, s68
Lsp_11:
    ds_read_b32 v20, v19 offset:256
    s_waitcnt lgkmcnt(0)
    v_readfirstlane_b32 s85, v20
    s_cmp_eq_u32 s85, 0
    s_cbranch_scc1 Lsp_11
    s_lshr_b32 s66, s85, 9
    s_cbranch_scc1 Lnoiss_9
Lgo_10:
    s_add_u32 s68, s85, s81
    s_bfe_u32 s45, s68, 0x10000
    s_lshl_b32 s45, s45, 8
    s_bfe_u32 s80, s68, 0x10001
    s_lshl_b32 s80, s80, 10
    s_add_u32 s45, s45, s80
    s_bfe_u32 s80, s68, 0x10002
    s_lshl_b32 s80, s80, 12
    s_add_u32 s45, s45, s80
    s_bfe_u32 s80, s68, 0x10003
    s_lshl_b32 s80, s80, 14
    s_add_u32 s45, s45, s80
    s_bfe_u32 s80, s68, 0x10004
    s_lshl_b32 s80, s80, 19
    s_add_u32 s45, s45, s80
    s_bfe_u32 s80, s68, 0x10005
    s_lshl_b32 s80, s80, 15
    s_add_u32 s45, s45, s80
    s_bfe_u32 s80, s68, 0x10006
    s_lshl_b32 s80, s80, 18
    s_add_u32 s45, s45, s80
    s_bfe_u32 s80, s68, 0x10007
    s_lshl_b32 s80, s80, 13
    s_add_u32 s45, s45, s80
    s_bfe_u32 s80, s68, 0x10008
    s_lshl_b32 s80, s80, 20
    s_add_u32 s68, s45, s80
    buffer_load_dwordx4 v[104:107], v1, s[28:31], s68 offen offset:0 nt
    buffer_load_dwordx4 v[108:111], v1, s[28:31], s68 offen offset:64 nt
    buffer_load_dwordx4 v[112:115], v1, s[28:31], s68 offen offset:128 nt
    buffer_load_dwordx4 v[116:119], v1, s[28:31], s68 offen offset:192 nt
    buffer_load_dwordx4 v[120:123], v2, s[32:35], s68 offen offset:0 nt
    buffer_load_dwordx4 v[124:127], v2, s[32:35], s68 offen offset:512 nt
    buffer_load_dwordx4 v[128:131], v2, s[32:35], s68 offen offset:2048 nt
    buffer_load_dwordx4 v[132:135], v2, s[32:35], s68 offen offset:2560 nt
Lnoiss_9:
    s_mov_b32 s67, 0
    s_branch L_Acommon
L_Astream:
    s_waitcnt vmcnt(0)
    s_waitcnt lgkmcnt(0)
    s_mov_b64 exec, 1
    v_mov_b32 v8, 1
    ds_add_u32 v7, v8 offset:40
    s_mov_b64 exec, -1
Llw_12:
    ds_read_b32 v8, v7 offset:32
    s_waitcnt lgkmcnt(0)
    v_readfirstlane_b32 s60, v8
    s_cmp_ge_u32 s60, 4
    s_cbranch_scc1 Llwd_13
    s_branch Llw_12
Llwd_13:
    s_setprio 0
    s_add_u32 s68, s64, -1
    s_lshr_b32 s84, s68, 2
    s_lshl_b32 s84, s84, 5
    s_add_u32 s84, s84, s65
    s_and_b32 s80, s68, 3
    s_add_u32 s84, s84, s80
    s_add_u32 s68, s84, s81
    s_bfe_u32 s45, s68, 0x10000
    s_lshl_b32 s45, s45, 8
    s_bfe_u32 s80, s68, 0x10001
    s_lshl_b32 s80, s80, 10
    s_add_u32 s45, s45, s80
    s_bfe_u32 s80, s68, 0x10002
    s_lshl_b32 s80, s80, 12
    s_add_u32 s45, s45, s80
    s_bfe_u32 s80, s68, 0x10003
    s_lshl_b32 s80, s80, 14
    s_add_u32 s45, s45, s80
    s_bfe_u32 s80, s68, 0x10004
    s_lshl_b32 s80, s80, 19
    s_add_u32 s45, s45, s80
    s_bfe_u32 s80, s68, 0x10005
    s_lshl_b32 s80, s80, 15
    s_add_u32 s45, s45, s80
    s_bfe_u32 s80, s68, 0x10006
    s_lshl_b32 s80, s80, 18
    s_add_u32 s45, s45, s80
    s_bfe_u32 s80, s68, 0x10007
    s_lshl_b32 s80, s80, 13
    s_add_u32 s45, s45, s80
    s_bfe_u32 s80, s68, 0x10008
    s_lshl_b32 s80, s80, 20
    s_add_u32 s68, s45, s80
    buffer_load_dwordx4 v[72:75], v1, s[28:31], s68 offen offset:0 nt
    buffer_load_dwordx4 v[76:79], v1, s[28:31], s68 offen offset:64 nt
    buffer_load_dwordx4 v[80:83], v1, s[28:31], s68 offen offset:128 nt
    buffer_load_dwordx4 v[84:87], v1, s[28:31], s68 offen offset:192 nt
    buffer_load_dwordx4 v[88:91], v2, s[32:35], s68 offen offset:0 nt
    buffer_load_dwordx4 v[92:95], v2, s[32:35], s68 offen offset:512 nt
    buffer_load_dwordx4 v[96:99], v2, s[32:35], s68 offen offset:2048 nt
    buffer_load_dwordx4 v[100:103], v2, s[32:35], s68 offen offset:2560 nt
Lnoiss_14:
    s_add_u32 s68, s64, 2
    s_lshr_b32 s85, s68, 2
    s_lshl_b32 s85, s85, 5
    s_add_u32 s85, s85, s65
    s_and_b32 s80, s68, 3
    s_add_u32 s85, s85, s80
    s_add_u32 s68, s85, s81
    s_bfe_u32 s45, s68, 0x10000
    s_lshl_b32 s45, s45, 8
    s_bfe_u32 s80, s68, 0x10001
    s_lshl_b32 s80, s80, 10
    s_add_u32 s45, s45, s80
    s_bfe_u32 s80, s68, 0x10002
    s_lshl_b32 s80, s80, 12
    s_add_u32 s45, s45, s80
    s_bfe_u32 s80, s68, 0x10003
    s_lshl_b32 s80, s80, 14
    s_add_u32 s45, s45, s80
    s_bfe_u32 s80, s68, 0x10004
    s_lshl_b32 s80, s80, 19
    s_add_u32 s45, s45, s80
    s_bfe_u32 s80, s68, 0x10005
    s_lshl_b32 s80, s80, 15
    s_add_u32 s45, s45, s80
    s_bfe_u32 s80, s68, 0x10006
    s_lshl_b32 s80, s80, 18
    s_add_u32 s45, s45, s80
    s_bfe_u32 s80, s68, 0x10007
    s_lshl_b32 s80, s80, 13
    s_add_u32 s45, s45, s80
    s_bfe_u32 s80, s68, 0x10008
    s_lshl_b32 s80, s80, 20
    s_add_u32 s68, s45, s80
    buffer_load_dwordx4 v[104:107], v1, s[28:31], s68 offen offset:0 nt
    buffer_load_dwordx4 v[108:111], v1, s[28:31], s68 offen offset:64 nt
    buffer_load_dwordx4 v[112:115], v1, s[28:31], s68 offen offset:128 nt
    buffer_load_dwordx4 v[116:119], v1, s[28:31], s68 offen offset:192 nt
    buffer_load_dwordx4 v[120:123], v2, s[32:35], s68 offen offset:0 nt
    buffer_load_dwordx4 v[124:127], v2, s[32:35], s68 offen offset:512 nt
    buffer_load_dwordx4 v[128:131], v2, s[32:35], s68 offen offset:2048 nt
    buffer_load_dwordx4 v[132:135], v2, s[32:35], s68 offen offset:2560 nt
Lnoiss_15:
    s_add_u32 s68, s64, 5
    s_lshr_b32 s86, s68, 2
    s_lshl_b32 s86, s86, 5
    s_add_u32 s86, s86, s65
    s_branch L_blks1
.p2align 12
L_blk1:
    s_branch L_blkret
L_blks1:
    s_and_b32 s80, s68, 3
    s_add_u32 s86, s86, s80
    s_add_u32 s68, s86, s81
    s_bfe_u32 s45, s68, 0x10000
    s_lshl_b32 s45, s45, 8
    s_bfe_u32 s80, s68, 0x10001
    s_lshl_b32 s80, s80, 10
    s_add_u32 s45, s45, s80
    s_bfe_u32 s80, s68, 0x10002
    s_lshl_b32 s80, s80, 12
    s_add_u32 s45, s45, s80
    s_bfe_u32 s80, s68, 0x10003
    s_lshl_b32 s80, s80, 14
    s_add_u32 s45, s45, s80
    s_bfe_u32 s80, s68, 0x10004
    s_lshl_b32 s80, s80, 19
    s_add_u32 s45, s45, s80
    s_bfe_u32 s80, s68, 0x10005
    s_lshl_b32 s80, s80, 15
    s_add_u32 s45, s45, s80
    s_bfe_u32 s80, s68, 0x10006
    s_lshl_b32 s80, s80, 18
    s_add_u32 s45, s45, s80
    s_bfe_u32 s80, s68, 0x10007
    s_lshl_b32 s80, s80, 13
    s_add_u32 s45, s45, s80
    s_bfe_u32 s80, s68, 0x10008
    s_lshl_b32 s80, s80, 20
    s_add_u32 s68, s45, s80
    buffer_load_dwordx4 v[136:139], v1, s[28:31], s68 offen offset:0 nt
    buffer_load_dwordx4 v[140:143], v1, s[28:31], s68 offen offset:64 nt
    buffer_load_dwordx4 v[144:147], v1, s[28:31], s68 offen offset:128 nt
    buffer_load_dwordx4 v[148:151], v1, s[28:31], s68 offen offset:192 nt
    buffer_load_dwordx4 v[152:155], v2, s[32:35], s68 offen offset:0 nt
    buffer_load_dwordx4 v[156:159], v2, s[32:35], s68 offen offset:512 nt
    buffer_load_dwordx4 v[160:163], v2, s[32:35], s68 offen offset:2048 nt
    buffer_load_dwordx4 v[164:167], v2, s[32:35], s68 offen offset:2560 nt
Lnoiss_16:
    s_add_u32 s68, s64, 8
    s_lshr_b32 s87, s68, 2
    s_lshl_b32 s87, s87, 5
    s_add_u32 s87, s87, s65
    s_and_b32 s80, s68, 3
    s_add_u32 s87, s87, s80
    s_add_u32 s68, s87, s81
    s_bfe_u32 s45, s68, 0x10000
    s_lshl_b32 s45, s45, 8
    s_bfe_u32 s80, s68, 0x10001
    s_lshl_b32 s80, s80, 10
    s_add_u32 s45, s45, s80
    s_bfe_u32 s80, s68, 0x10002
    s_lshl_b32 s80, s80, 12
    s_add_u32 s45, s45, s80
    s_bfe_u32 s80, s68, 0x10003
    s_lshl_b32 s80, s80, 14
    s_add_u32 s45, s45, s80
    s_bfe_u32 s80, s68, 0x10004
    s_lshl_b32 s80, s80, 19
    s_add_u32 s45, s45, s80
    s_bfe_u32 s80, s68, 0x10005
    s_lshl_b32 s80, s80, 15
    s_add_u32 s45, s45, s80
    s_bfe_u32 s80, s68, 0x10006
    s_lshl_b32 s80, s80, 18
    s_add_u32 s45, s45, s80
    s_bfe_u32 s80, s68, 0x10007
    s_lshl_b32 s80, s80, 13
    s_add_u32 s45, s45, s80
    s_bfe_u32 s80, s68, 0x10008
    s_lshl_b32 s80, s80, 20
    s_add_u32 s68, s45, s80
    buffer_load_dwordx4 v[168:171], v1, s[28:31], s68 offen offset:0 nt
    buffer_load_dwordx4 v[172:175], v1, s[28:31], s68 offen offset:64 nt
    buffer_load_dwordx4 v[176:179], v1, s[28:31], s68 offen offset:128 nt
    buffer_load_dwordx4 v[180:183], v1, s[28:31], s68 offen offset:192 nt
    buffer_load_dwordx4 v[184:187], v2, s[32:35], s68 offen offset:0 nt
    buffer_load_dwordx4 v[188:191], v2, s[32:35], s68 offen offset:512 nt
    buffer_load_dwordx4 v[192:195], v2, s[32:35], s68 offen offset:2048 nt
    buffer_load_dwordx4 v[196:199], v2, s[32:35], s68 offen offset:2560 nt
Lnoiss_17:
    s_add_u32 s68, s64, 11
    s_lshr_b32 s88, s68, 2
    s_lshl_b32 s88, s88, 5
    s_add_u32 s88, s88, s65
    s_and_b32 s80, s68, 3
    s_add_u32 s88, s88, s80
    s_add_u32 s68, s88, s81
    s_bfe_u32 s45, s68, 0x10000
    s_lshl_b32 s45, s45, 8
    s_bfe_u32 s80, s68, 0x10001
    s_lshl_b32 s80, s80, 10
    s_add_u32 s45, s45, s80
    s_bfe_u32 s80, s68, 0x10002
    s_lshl_b32 s80, s80, 12
    s_add_u32 s45, s45, s80
    s_bfe_u32 s80, s68, 0x10003
    s_lshl_b32 s80, s80, 14
    s_add_u32 s45, s45, s80
    s_bfe_u32 s80, s68, 0x10004
    s_lshl_b32 s80, s80, 19
    s_add_u32 s45, s45, s80
    s_bfe_u32 s80, s68, 0x10005
    s_lshl_b32 s80, s80, 15
    s_add_u32 s45, s45, s80
    s_bfe_u32 s80, s68, 0x10006
    s_lshl_b32 s80, s80, 18
    s_add_u32 s45, s45, s80
    s_bfe_u32 s80, s68, 0x10007
    s_lshl_b32 s80, s80, 13
    s_add_u32 s45, s45, s80
    s_bfe_u32 s80, s68, 0x10008
    s_lshl_b32 s80, s80, 20
    s_add_u32 s68, s45, s80
    buffer_load_dwordx4 v[200:203], v1, s[28:31], s68 offen offset:0 nt
    buffer_load_dwordx4 v[204:207], v1, s[28:31], s68 offen offset:64 nt
    buffer_load_dwordx4 v[208:211], v1, s[28:31], s68 offen offset:128 nt
    buffer_load_dwordx4 v[212:215], v1, s[28:31], s68 offen offset:192 nt
    buffer_load_dwordx4 v[216:219], v2, s[32:35], s68 offen offset:0 nt
    buffer_load_dwordx4 v[220:223], v2, s[32:35], s68 offen offset:512 nt
    buffer_load_dwordx4 v[224:227], v2, s[32:35], s68 offen offset:2048 nt
    buffer_load_dwordx4 v[228:231], v2, s[32:35], s68 offen offset:2560 nt
Lnoiss_18:
    s_mov_b32 s67, 1
L_Acommon:
    v_mov_b32 v40, 0
    v_mov_b32 v41, 0
    v_mov_b32 v42, 0
    v_mov_b32 v43, 0
    v_mov_b32 v44, 0
    v_mov_b32 v45, 0
    v_mov_b32 v46, 0
    v_mov_b32 v47, 0
    v_mov_b32 v48, 0
    v_mov_b32 v49, 0
    v_mov_b32 v50, 0
    v_mov_b32 v51, 0
    v_mov_b32 v52, 0
    v_mov_b32 v53, 0
    v_mov_b32 v54, 0
    v_mov_b32 v55, 0
    v_mov_b32 v56, 0
    v_mov_b32 v57, 0
    v_mov_b32 v58, 0
    v_mov_b32 v59, 0
    v_mov_b32 v60, 0
    v_mov_b32 v61, 0
    v_mov_b32 v62, 0
    v_mov_b32 v63, 0
    v_mov_b32 v64, 0
    v_mov_b32 v65, 0
    v_mov_b32 v66, 0
    v_mov_b32 v67, 0
    v_mov_b32 v68, 0
    v_mov_b32 v69, 0
    v_mov_b32 v70, 0
    v_mov_b32 v71, 0
    v_mov_b32 v3, 0xff800000
    v_mov_b32 v4, 0
    v_and_b32 v237, 15, v0
    v_lshrrev_b32 v238, 4, v0
    v_mul_u32_u24 v232, 528, v237
    v_lshl_add_u32 v232, v238, 7, v232
    s_mul_i32 s60, s64, 4224
    v_add_u32 v232, s60, v232
    s_lshl_b32 s60, s64, 3
    s_add_u32 s60, s60, 41728
    v_lshlrev_b32 v233, 5, v237
    v_add_u32 v233, s60, v233
    v_lshrrev_b32 v237, 5, v0
    s_lshl_b32 s60, s64, 1
    v_add_u32 v237, s60, v237
    v_and_b32 v238, 31, v0
    v_mul_u32_u24 v234, 528, v237
    v_lshl_add_u32 v234, v238, 4, v234
    v_lshlrev_b32 v235, 5, v237
    v_lshlrev_b32 v236, 9, v237
    v_lshl_add_u32 v236, v238, 4, v236
    s_lshl_b32 s71, s2, 12
    s_add_u32 s71, s71, 2097152
    s_mov_b32 s74, 0x07060500
    s_mov_b32 s75, 0x07060501
    s_mov_b32 s76, 0x07060502
    s_mov_b32 s77, 0x07060503
    s_mov_b32 s72, 0x00ff00ff
    s_mov_b32 s73, 0x00ff00ff
Llw_19:
    ds_read_b32 v8, v7 offset:8
    s_waitcnt lgkmcnt(0)
    v_readfirstlane_b32 s60, v8
    s_cmp_ge_u32 s60, 1
    s_cbranch_scc1 Llwd_20
    s_sleep 2
    s_branch Llw_19
Llwd_20:
    v_and_b32 v7, 7, v0
    v_mul_u32_u24 v7, 288, v7
    v_lshl_add_u32 v7, v6, 4, v7
    ds_read_b128 v[24:27], v7 offset:39424
    ds_read_b128 v[28:31], v7 offset:39488
    ds_read_b128 v[32:35], v7 offset:39552
    ds_read_b128 v[36:39], v7 offset:39616
    s_mov_b32 s69, 0x3fb8aa3b
    s_mov_b32 s70, 0x3db504f3
    s_waitcnt lgkmcnt(0)
L_Aloop:
    s_cmp_ge_u32 s84, 512
    s_cbranch_scc1 L_Adone
    s_waitcnt vmcnt(12)
    s_cmp_lt_u32 s85, 512
    s_cbranch_scc1 Lw_21
    s_waitcnt vmcnt(4)
Lw_21:
    v_mfma_f32_16x16x32_bf16 v[10:13], v[72:75], v[24:27], 0
    v_mfma_f32_16x16x32_bf16 v[10:13], v[76:79], v[28:31], v[10:13]
    v_mfma_f32_16x16x32_bf16 v[10:13], v[80:83], v[32:35], v[10:13]
    v_mfma_f32_16x16x32_bf16 v[10:13], v[84:87], v[36:39], v[10:13]
    s_nop 7
    v_cvt_pk_bf16_f32 v5, v10, v11
    v_cvt_pk_bf16_f32 v6, v12, v13
    v_lshlrev_b32 v10, 16, v5
    v_and_b32 v11, 0xffff0000, v5
    v_lshlrev_b32 v12, 16, v6
    v_and_b32 v13, 0xffff0000, v6
    v_mul_f32 v10, s70, v10
    v_mul_f32 v11, s70, v11
    v_mul_f32 v12, s70, v12
    v_mul_f32 v13, s70, v13
    v_cvt_pk_bf16_f32 v5, v10, v11
    v_cvt_pk_bf16_f32 v6, v12, v13
    v_lshlrev_b32 v10, 16, v5
    v_and_b32 v11, 0xffff0000, v5
    v_lshlrev_b32 v12, 16, v6
    v_and_b32 v13, 0xffff0000, v6
    v_max3_f32 v7, v10, v11, v12
    v_max3_f32 v7, v7, v13, v3
    v_mov_b32 v5, v7
    v_mov_b32 v6, v7
    s_nop 1
    v_permlane16_swap_b32 v5, v6
    s_nop 1
    v_max_f32 v7, v5, v6
    v_mov_b32 v5, v7
    v_mov_b32 v6, v7
    s_nop 1
    v_permlane32_swap_b32 v5, v6
    s_nop 1
    v_max_f32 v7, v5, v6
    v_sub_f32 v8, v3, v7
    v_mul_f32 v8, s69, v8
    v_exp_f32 v8, v8
    v_mov_b32 v3, v7
    v_mul_f32 v7, s69, v7
    v_fma_f32 v10, v10, s69, -v7
    v_fma_f32 v11, v11, s69, -v7
    v_fma_f32 v12, v12, s69, -v7
    v_fma_f32 v13, v13, s69, -v7
    v_exp_f32 v10, v10
    v_exp_f32 v11, v11
    v_exp_f32 v12, v12
    v_exp_f32 v13, v13
    v_mul_f32 v4, v4, v8
    v_add_f32 v5, v10, v11
    v_add_f32 v6, v12, v13
    v_cvt_pk_bf16_f32 v14, v10, v11
    v_cvt_pk_bf16_f32 v15, v12, v13
    v_add_f32 v4, v4, v5
    v_add_f32 v4, v4, v6
    v_cmp_neq_f32 vcc, 1.0, v8
    s_cbranch_vccz Lnors_22
    v_mul_f32 v40, v40, v8
    v_mul_f32 v41, v41, v8
    v_mul_f32 v42, v42, v8
    v_mul_f32 v43, v43, v8
    v_mul_f32 v44, v44, v8
    v_mul_f32 v45, v45, v8
    v_mul_f32 v46, v46, v8
    v_mul_f32 v47, v47, v8
    v_mul_f32 v48, v48, v8
    v_mul_f32 v49, v49, v8
    v_mul_f32 v50, v50, v8
    v_mul_f32 v51, v51, v8
    v_mul_f32 v52, v52, v8
    v_mul_f32 v53, v53, v8
    v_mul_f32 v54, v54, v8
    v_mul_f32 v55, v55, v8
    v_mul_f32 v56, v56, v8
    v_mul_f32 v57, v57, v8
    v_mul_f32 v58, v58, v8
    v_mul_f32 v59, v59, v8
    v_mul_f32 v60, v60, v8
    v_mul_f32 v61, v61, v8
    v_mul_f32 v62, v62, v8
    v_mul_f32 v63, v63, v8
    v_mul_f32 v64, v64, v8
    v_mul_f32 v65, v65, v8
    v_mul_f32 v66, v66, v8
    v_mul_f32 v67, v67, v8
    v_mul_f32 v68, v68, v8
    v_mul_f32 v69, v69, v8
    v_mul_f32 v70, v70, v8
    v_mul_f32 v71, v71, v8
Lnors_22:
    s_waitcnt vmcnt(8)
    s_cmp_lt_u32 s85, 512
    s_cbranch_scc1 Lw_23
    s_waitcnt vmcnt(0)
Lw_23:
    s_mov_b64 exec, 1
    ds_add_rtn_u32 v23, v21, v22 offset:20
    s_mov_b64 exec, -1
    v_perm_b32 v16, v92, v88, s58
    v_perm_b32 v17, v100, v96, s58
    s_nop 1
    v_mfma_f32_16x16x16_bf16 v[40:43], v[16:17], v[14:15], v[40:43]
    v_perm_b32 v18, v92, v88, s59
    v_perm_b32 v19, v100, v96, s59
    s_nop 1
    v_mfma_f32_16x16x16_bf16 v[44:47], v[18:19], v[14:15], v[44:47]
    v_perm_b32 v16, v93, v89, s58
    v_perm_b32 v17, v101, v97, s58
    s_nop 1
    v_mfma_f32_16x16x16_bf16 v[48:51], v[16:17], v[14:15], v[48:51]
    v_perm_b32 v18, v93, v89, s59
    v_perm_b32 v19, v101, v97, s59
    s_nop 1
    v_mfma_f32_16x16x16_bf16 v[52:55], v[18:19], v[14:15], v[52:55]
    v_perm_b32 v16, v94, v90, s58
    v_perm_b32 v17, v102, v98, s58
    s_nop 1
    v_mfma_f32_16x16x16_bf16 v[56:59], v[16:17], v[14:15], v[56:59]
    v_perm_b32 v18, v94, v90, s59
    v_perm_b32 v19, v102, v98, s59
    s_nop 1
    v_mfma_f32_16x16x16_bf16 v[60:63], v[18:19], v[14:15], v[60:63]
    v_perm_b32 v16, v95, v91, s58
    v_perm_b32 v17, v103, v99, s58
    s_nop 1
    v_mfma_f32_16x16x16_bf16 v[64:67], v[16:17], v[14:15], v[64:67]
    v_perm_b32 v18, v95, v91, s59
    v_perm_b32 v19, v103, v99, s59
    s_nop 1
    v_mfma_f32_16x16x16_bf16 v[68:71], v[18:19], v[14:15], v[68:71]
    s_movk_i32 s84, 0x7fff
    s_cmp_lg_u32 s66, 0
    s_cbranch_scc1 Lnoiss_24
    s_waitcnt lgkmcnt(0)
    v_readfirstlane_b32 s68, v23
    s_lshr_b32 s84, s68, 2
    s_lshl_b32 s84, s84, 5
    s_add_u32 s84, s84, s65
    s_and_b32 s80, s68, 3
    s_add_u32 s84, s84, s80
    s_cmp_lt_u32 s68, s95
    s_cbranch_scc1 Lgo_25
    s_sub_u32 s68, s68, s95
    s_lshl_b32 s68, s68, 2
    v_mov_b32 v19, s68
Lsp_26:
    ds_read_b32 v20, v19 offset:256
    s_waitcnt lgkmcnt(0)
    v_readfirstlane_b32 s84, v20
    s_cmp_eq_u32 s84, 0
    s_cbranch_scc1 Lsp_26
    s_lshr_b32 s66, s84, 9
    s_cbranch_scc1 Lnoiss_24
Lgo_25:
    s_add_u32 s68, s84, s81
    s_bfe_u32 s45, s68, 0x10000
    s_lshl_b32 s45, s45, 8
    s_bfe_u32 s80, s68, 0x10001
    s_lshl_b32 s80, s80, 10
    s_add_u32 s45, s45, s80
    s_bfe_u32 s80, s68, 0x10002
    s_lshl_b32 s80, s80, 12
    s_add_u32 s45, s45, s80
    s_bfe_u32 s80, s68, 0x10003
    s_lshl_b32 s80, s80, 14
    s_add_u32 s45, s45, s80
    s_bfe_u32 s80, s68, 0x10004
    s_lshl_b32 s80, s80, 19
    s_add_u32 s45, s45, s80
    s_bfe_u32 s80, s68, 0x10005
    s_lshl_b32 s80, s80, 15
    s_add_u32 s45, s45, s80
    s_bfe_u32 s80, s68, 0x10006
    s_lshl_b32 s80, s80, 18
    s_add_u32 s45, s45, s80
    s_bfe_u32 s80, s68, 0x10007
    s_lshl_b32 s80, s80, 13
    s_add_u32 s45, s45, s80
    s_bfe_u32 s80, s68, 0x10008
    s_lshl_b32 s80, s80, 20
    s_add_u32 s68, s45, s80
    buffer_load_dwordx4 v[72:75], v1, s[28:31], s68 offen offset:0 nt
    buffer_load_dwordx4 v[76:79], v1, s[28:31], s68 offen offset:64 nt
    buffer_load_dwordx4 v[80:83], v1, s[28:31], s68 offen offset:128 nt
    buffer_load_dwordx4 v[84:87], v1, s[28:31], s68 offen offset:192 nt
    buffer_load_dwordx4 v[88:91], v2, s[32:35], s68 offen offset:0 nt
    buffer_load_dwordx4 v[92:95], v2, s[32:35], s68 offen offset:512 nt
    buffer_load_dwordx4 v[96:99], v2, s[32:35], s68 offen offset:2048 nt
    buffer_load_dwordx4 v[100:103], v2, s[32:35], s68 offen offset:2560 nt
Lnoiss_24:
    s_cmp_ge_u32 s85, 512
    s_cbranch_scc1 L_Adone
    s_waitcnt vmcnt(12)
    s_cmp_lt_u32 s84, 512
    s_cbranch_scc1 Lw_27
    s_waitcnt vmcnt(4)
Lw_27:
    v_mfma_f32_16x16x32_bf16 v[10:13], v[104:107], v[24:27], 0
    v_mfma_f32_16x16x32_bf16 v[10:13], v[108:111], v[28:31], v[10:13]
    v_mfma_f32_16x16x32_bf16 v[10:13], v[112:115], v[32:35], v[10:13]
    v_mfma_f32_16x16x32_bf16 v[10:13], v[116:119], v[36:39], v[10:13]
    s_nop 7
    v_cvt_pk_bf16_f32 v5, v10, v11
    v_cvt_pk_bf16_f32 v6, v12, v13
    v_lshlrev_b32 v10, 16, v5
    v_and_b32 v11, 0xffff0000, v5
    v_lshlrev_b32 v12, 16, v6
    v_and_b32 v13, 0xffff0000, v6
    v_mul_f32 v10, s70, v10
    v_mul_f32 v11, s70, v11
    v_mul_f32 v12, s70, v12
    v_mul_f32 v13, s70, v13
    v_cvt_pk_bf16_f32 v5, v10, v11
    v_cvt_pk_bf16_f32 v6, v12, v13
    v_lshlrev_b32 v10, 16, v5
    v_and_b32 v11, 0xffff0000, v5
    v_lshlrev_b32 v12, 16, v6
    v_and_b32 v13, 0xffff0000, v6
    v_max3_f32 v7, v10, v11, v12
    v_max3_f32 v7, v7, v13, v3
    v_mov_b32 v5, v7
    v_mov_b32 v6, v7
    s_nop 1
    v_permlane16_swap_b32 v5, v6
    s_nop 1
    v_max_f32 v7, v5, v6
    v_mov_b32 v5, v7
    v_mov_b32 v6, v7
    s_nop 1
    v_permlane32_swap_b32 v5, v6
    s_nop 1
    v_max_f32 v7, v5, v6
    v_sub_f32 v8, v3, v7
    v_mul_f32 v8, s69, v8
    v_exp_f32 v8, v8
    v_mov_b32 v3, v7
    v_mul_f32 v7, s69, v7
    v_fma_f32 v10, v10, s69, -v7
    v_fma_f32 v11, v11, s69, -v7
    v_fma_f32 v12, v12, s69, -v7
    v_fma_f32 v13, v13, s69, -v7
    v_exp_f32 v10, v10
    v_exp_f32 v11, v11
    v_exp_f32 v12, v12
    v_exp_f32 v13, v13
    v_mul_f32 v4, v4, v8
    v_add_f32 v5, v10, v11
    v_add_f32 v6, v12, v13
    v_cvt_pk_bf16_f32 v14, v10, v11
    v_cvt_pk_bf16_f32 v15, v12, v13
    v_add_f32 v4, v4, v5
    v_add_f32 v4, v4, v6
    v_cmp_neq_f32 vcc, 1.0, v8
    s_cbranch_vccz Lnors_28
    v_mul_f32 v40, v40, v8
    v_mul_f32 v41, v41, v8
    v_mul_f32 v42, v42, v8
    v_mul_f32 v43, v43, v8
    v_mul_f32 v44, v44, v8
    v_mul_f32 v45, v45, v8
    v_mul_f32 v46, v46, v8
    v_mul_f32 v47, v47, v8
    v_mul_f32 v48, v48, v8
    v_mul_f32 v49, v49, v8
    v_mul_f32 v50, v50, v8
    v_mul_f32 v51, v51, v8
    v_mul_f32 v52, v52, v8
    v_mul_f32 v53, v53, v8
    v_mul_f32 v54, v54, v8
    v_mul_f32 v55, v55, v8
    v_mul_f32 v56, v56, v8
    v_mul_f32 v57, v57, v8
    v_mul_f32 v58, v58, v8
    v_mul_f32 v59, v59, v8
    v_mul_f32 v60, v60, v8
    v_mul_f32 v61, v61, v8
    v_mul_f32 v62, v62, v8
    v_mul_f32 v63, v63, v8
    v_mul_f32 v64, v64, v8
    v_mul_f32 v65, v65, v8
    v_mul_f32 v66, v66, v8
    v_mul_f32 v67, v67, v8
    v_mul_f32 v68, v68, v8
    v_mul_f32 v69, v69, v8
    v_mul_f32 v70, v70, v8
    v_mul_f32 v71, v71, v8
Lnors_28:
    s_waitcnt vmcnt(8)
    s_cmp_lt_u32 s84, 512
    s_cbranch_scc1 Lw_29
    s_waitcnt vmcnt(0)
Lw_29:
    s_mov_b64 exec, 1
    ds_add_rtn_u32 v23, v21, v22 offset:20
    s_mov_b64 exec, -1
    v_perm_b32 v16, v124, v120, s58
    v_perm_b32 v17, v132, v128, s58
    s_nop 1
    v_mfma_f32_16x16x16_bf16 v[40:43], v[16:17], v[14:15], v[40:43]
    v_perm_b32 v18, v124, v120, s59
    v_perm_b32 v19, v132, v128, s59
    s_nop 1
    v_mfma_f32_16x16x16_bf16 v[44:47], v[18:19], v[14:15], v[44:47]
    v_perm_b32 v16, v125, v121, s58
    v_perm_b32 v17, v133, v129, s58
    s_nop 1
    v_mfma_f32_16x16x16_bf16 v[48:51], v[16:17], v[14:15], v[48:51]
    v_perm_b32 v18, v125, v121, s59
    v_perm_b32 v19, v133, v129, s59
    s_nop 1
    v_mfma_f32_16x16x16_bf16 v[52:55], v[18:19], v[14:15], v[52:55]
    v_perm_b32 v16, v126, v122, s58
    v_perm_b32 v17, v134, v130, s58
    s_nop 1
    v_mfma_f32_16x16x16_bf16 v[56:59], v[16:17], v[14:15], v[56:59]
    v_perm_b32 v18, v126, v122, s59
    v_perm_b32 v19, v134, v130, s59
    s_nop 1
    v_mfma_f32_16x16x16_bf16 v[60:63], v[18:19], v[14:15], v[60:63]
    v_perm_b32 v16, v127, v123, s58
    v_perm_b32 v17, v135, v131, s58
    s_nop 1
    v_mfma_f32_16x16x16_bf16 v[64:67], v[16:17], v[14:15], v[64:67]
    v_perm_b32 v18, v127, v123, s59
    v_perm_b32 v19, v135, v131, s59
    s_nop 1
    v_mfma_f32_16x16x16_bf16 v[68:71], v[18:19], v[14:15], v[68:71]
    s_movk_i32 s85, 0x7fff
    s_cmp_lg_u32 s66, 0
    s_cbranch_scc1 Lnoiss_30
    s_waitcnt lgkmcnt(0)
    v_readfirstlane_b32 s68, v23
    s_lshr_b32 s85, s68, 2
    s_lshl_b32 s85, s85, 5
    s_add_u32 s85, s85, s65
    s_and_b32 s80, s68, 3
    s_add_u32 s85, s85, s80
    s_cmp_lt_u32 s68, s95
    s_cbranch_scc1 Lgo_31
    s_sub_u32 s68, s68, s95
    s_lshl_b32 s68, s68, 2
    v_mov_b32 v19, s68
Lsp_32:
    ds_read_b32 v20, v19 offset:256
    s_waitcnt lgkmcnt(0)
    v_readfirstlane_b32 s85, v20
    s_cmp_eq_u32 s85, 0
    s_cbranch_scc1 Lsp_32
    s_lshr_b32 s66, s85, 9
    s_cbranch_scc1 Lnoiss_30
Lgo_31:
    s_add_u32 s68, s85, s81
    s_bfe_u32 s45, s68, 0x10000
    s_lshl_b32 s45, s45, 8
    s_bfe_u32 s80, s68, 0x10001
    s_lshl_b32 s80, s80, 10
    s_add_u32 s45, s45, s80
    s_bfe_u32 s80, s68, 0x10002
    s_lshl_b32 s80, s80, 12
    s_add_u32 s45, s45, s80
    s_bfe_u32 s80, s68, 0x10003
    s_lshl_b32 s80, s80, 14
    s_add_u32 s45, s45, s80
    s_bfe_u32 s80, s68, 0x10004
    s_lshl_b32 s80, s80, 19
    s_add_u32 s45, s45, s80
    s_bfe_u32 s80, s68, 0x10005
    s_lshl_b32 s80, s80, 15
    s_add_u32 s45, s45, s80
    s_bfe_u32 s80, s68, 0x10006
    s_lshl_b32 s80, s80, 18
    s_add_u32 s45, s45, s80
    s_bfe_u32 s80, s68, 0x10007
    s_lshl_b32 s80, s80, 13
    s_add_u32 s45, s45, s80
    s_bfe_u32 s80, s68, 0x10008
    s_lshl_b32 s80, s80, 20
    s_add_u32 s68, s45, s80
    buffer_load_dwordx4 v[104:107], v1, s[28:31], s68 offen offset:0 nt
    buffer_load_dwordx4 v[108:111], v1, s[28:31], s68 offen offset:64 nt
    buffer_load_dwordx4 v[112:115], v1, s[28:31], s68 offen offset:128 nt
    buffer_load_dwordx4 v[116:119], v1, s[28:31], s68 offen offset:192 nt
    buffer_load_dwordx4 v[120:123], v2, s[32:35], s68 offen offset:0 nt
    buffer_load_dwordx4 v[124:127], v2, s[32:35], s68 offen offset:512 nt
    buffer_load_dwordx4 v[128:131], v2, s[32:35], s68 offen offset:2048 nt
    buffer_load_dwordx4 v[132:135], v2, s[32:35], s68 offen offset:2560 nt
Lnoiss_30:
    s_cmp_eq_u32 s67, 0
    s_cbranch_scc1 L_Aloop
    s_mov_b32 s67, 0
    s_waitcnt vmcnt(36)
    s_cmp_lt_u32 s85, 512
    s_cbranch_scc1 Lw_33
    s_waitcnt vmcnt(0)
Lw_33:
    v_mfma_f32_16x16x32_bf16 v[10:13], v[136:139], v[24:27], 0
    v_mfma_f32_16x16x32_bf16 v[10:13], v[140:143], v[28:31], v[10:13]
    v_mfma_f32_16x16x32_bf16 v[10:13], v[144:147], v[32:35], v[10:13]
    v_mfma_f32_16x16x32_bf16 v[10:13], v[148:151], v[36:39], v[10:13]
    s_nop 7
    v_cvt_pk_bf16_f32 v5, v10, v11
    v_cvt_pk_bf16_f32 v6, v12, v13
    v_lshlrev_b32 v10, 16, v5
    v_and_b32 v11, 0xffff0000, v5
    v_lshlrev_b32 v12, 16, v6
    v_and_b32 v13, 0xffff0000, v6
    v_mul_f32 v10, s70, v10
    v_mul_f32 v11, s70, v11
    v_mul_f32 v12, s70, v12
    v_mul_f32 v13, s70, v13
    v_cvt_pk_bf16_f32 v5, v10, v11
    v_cvt_pk_bf16_f32 v6, v12, v13
    v_lshlrev_b32 v10, 16, v5
    v_and_b32 v11, 0xffff0000, v5
    v_lshlrev_b32 v12, 16, v6
    v_and_b32 v13, 0xffff0000, v6
    v_max3_f32 v7, v10, v11, v12
    v_max3_f32 v7, v7, v13, v3
    v_mov_b32 v5, v7
    v_mov_b32 v6, v7
    s_nop 1
    v_permlane16_swap_b32 v5, v6
    s_nop 1
    v_max_f32 v7, v5, v6
    v_mov_b32 v5, v7
    v_mov_b32 v6, v7
    s_nop 1
    v_permlane32_swap_b32 v5, v6
    s_nop 1
    v_max_f32 v7, v5, v6
    v_sub_f32 v8, v3, v7
    v_mul_f32 v8, s69, v8
    v_exp_f32 v8, v8
    v_mov_b32 v3, v7
    v_mul_f32 v7, s69, v7
    v_fma_f32 v10, v10, s69, -v7
    v_fma_f32 v11, v11, s69, -v7
    v_fma_f32 v12, v12, s69, -v7
    v_fma_f32 v13, v13, s69, -v7
    v_exp_f32 v10, v10
    v_exp_f32 v11, v11
    v_exp_f32 v12, v12
    v_exp_f32 v13, v13
    v_mul_f32 v4, v4, v8
    v_add_f32 v5, v10, v11
    v_add_f32 v6, v12, v13
    v_cvt_pk_bf16_f32 v14, v10, v11
    v_cvt_pk_bf16_f32 v15, v12, v13
    v_add_f32 v4, v4, v5
    v_add_f32 v4, v4, v6
    v_cmp_neq_f32 vcc, 1.0, v8
    s_cbranch_vccz Lnors_34
    v_mul_f32 v40, v40, v8
    v_mul_f32 v41, v41, v8
    v_mul_f32 v42, v42, v8
    v_mul_f32 v43, v43, v8
    v_mul_f32 v44, v44, v8
    v_mul_f32 v45, v45, v8
    v_mul_f32 v46, v46, v8
    v_mul_f32 v47, v47, v8
    v_mul_f32 v48, v48, v8
    v_mul_f32 v49, v49, v8
    v_mul_f32 v50, v50, v8
    v_mul_f32 v51, v51, v8
    v_mul_f32 v52, v52, v8
    v_mul_f32 v53, v53, v8
    v_mul_f32 v54, v54, v8
    v_mul_f32 v55, v55, v8
    v_mul_f32 v56, v56, v8
    v_mul_f32 v57, v57, v8
    v_mul_f32 v58, v58, v8
    v_mul_f32 v59, v59, v8
    v_mul_f32 v60, v60, v8
    v_mul_f32 v61, v61, v8
    v_mul_f32 v62, v62, v8
    v_mul_f32 v63, v63, v8
    v_mul_f32 v64, v64, v8
    v_mul_f32 v65, v65, v8
    v_mul_f32 v66, v66, v8
    v_mul_f32 v67, v67, v8
    v_mul_f32 v68, v68, v8
    v_mul_f32 v69, v69, v8
    v_mul_f32 v70, v70, v8
    v_mul_f32 v71, v71, v8
Lnors_34:
    s_waitcnt vmcnt(32)
    s_cmp_lt_u32 s85, 512
    s_cbranch_scc1 Lw_35
    s_waitcnt vmcnt(0)
Lw_35:
    v_perm_b32 v16, v156, v152, s58
    v_perm_b32 v17, v164, v160, s58
    s_nop 1
    v_mfma_f32_16x16x16_bf16 v[40:43], v[16:17], v[14:15], v[40:43]
    v_perm_b32 v18, v156, v152, s59
    v_perm_b32 v19, v164, v160, s59
    s_nop 1
    v_mfma_f32_16x16x16_bf16 v[44:47], v[18:19], v[14:15], v[44:47]
    v_perm_b32 v16, v157, v153, s58
    v_perm_b32 v17, v165, v161, s58
    s_nop 1
    v_mfma_f32_16x16x16_bf16 v[48:51], v[16:17], v[14:15], v[48:51]
    v_perm_b32 v18, v157, v153, s59
    v_perm_b32 v19, v165, v161, s59
    s_nop 1
    v_mfma_f32_16x16x16_bf16 v[52:55], v[18:19], v[14:15], v[52:55]
    v_perm_b32 v16, v158, v154, s58
    v_perm_b32 v17, v166, v162, s58
    s_nop 1
    v_mfma_f32_16x16x16_bf16 v[56:59], v[16:17], v[14:15], v[56:59]
    v_perm_b32 v18, v158, v154, s59
    v_perm_b32 v19, v166, v162, s59
    s_nop 1
    v_mfma_f32_16x16x16_bf16 v[60:63], v[18:19], v[14:15], v[60:63]
    v_perm_b32 v16, v159, v155, s58
    v_perm_b32 v17, v167, v163, s58
    s_nop 1
    v_mfma_f32_16x16x16_bf16 v[64:67], v[16:17], v[14:15], v[64:67]
    v_perm_b32 v18, v159, v155, s59
    v_perm_b32 v19, v167, v163, s59
    s_nop 1
    v_mfma_f32_16x16x16_bf16 v[68:71], v[18:19], v[14:15], v[68:71]
    s_waitcnt vmcnt(28)
    s_cmp_lt_u32 s85, 512
    s_cbranch_scc1 Lw_36
    s_waitcnt vmcnt(0)
Lw_36:
    v_mfma_f32_16x16x32_bf16 v[10:13], v[168:171], v[24:27], 0
    v_mfma_f32_16x16x32_bf16 v[10:13], v[172:175], v[28:31], v[10:13]
    v_mfma_f32_16x16x32_bf16 v[10:13], v[176:179], v[32:35], v[10:13]
    v_mfma_f32_16x16x32_bf16 v[10:13], v[180:183], v[36:39], v[10:13]
    s_nop 7
    v_cvt_pk_bf16_f32 v5, v10, v11
    v_cvt_pk_bf16_f32 v6, v12, v13
    v_lshlrev_b32 v10, 16, v5
    v_and_b32 v11, 0xffff0000, v5
    v_lshlrev_b32 v12, 16, v6
    v_and_b32 v13, 0xffff0000, v6
    v_mul_f32 v10, s70, v10
    v_mul_f32 v11, s70, v11
    v_mul_f32 v12, s70, v12
    v_mul_f32 v13, s70, v13
    v_cvt_pk_bf16_f32 v5, v10, v11
    v_cvt_pk_bf16_f32 v6, v12, v13
    v_lshlrev_b32 v10, 16, v5
    v_and_b32 v11, 0xffff0000, v5
    v_lshlrev_b32 v12, 16, v6
    v_and_b32 v13, 0xffff0000, v6
    v_max3_f32 v7, v10, v11, v12
    v_max3_f32 v7, v7, v13, v3
    v_mov_b32 v5, v7
    v_mov_b32 v6, v7
    s_nop 1
    v_permlane16_swap_b32 v5, v6
    s_nop 1
    v_max_f32 v7, v5, v6
    v_mov_b32 v5, v7
    v_mov_b32 v6, v7
    s_nop 1
    v_permlane32_swap_b32 v5, v6
    s_nop 1
    v_max_f32 v7, v5, v6
    v_sub_f32 v8, v3, v7
    v_mul_f32 v8, s69, v8
    v_exp_f32 v8, v8
    s_branch L_blks2
.p2align 12
L_blk2:
    s_branch L_blkret
L_blks2:
    v_mov_b32 v3, v7
    v_mul_f32 v7, s69, v7
    v_fma_f32 v10, v10, s69, -v7
    v_fma_f32 v11, v11, s69, -v7
    v_fma_f32 v12, v12, s69, -v7
    v_fma_f32 v13, v13, s69, -v7
    v_exp_f32 v10, v10
    v_exp_f32 v11, v11
    v_exp_f32 v12, v12
    v_exp_f32 v13, v13
    v_mul_f32 v4, v4, v8
    v_add_f32 v5, v10, v11
    v_add_f32 v6, v12, v13
    v_cvt_pk_bf16_f32 v14, v10, v11
    v_cvt_pk_bf16_f32 v15, v12, v13
    v_add_f32 v4, v4, v5
    v_add_f32 v4, v4, v6
    v_cmp_neq_f32 vcc, 1.0, v8
    s_cbranch_vccz Lnors_37
    v_mul_f32 v40, v40, v8
    v_mul_f32 v41, v41, v8
    v_mul_f32 v42, v42, v8
    v_mul_f32 v43, v43, v8
    v_mul_f32 v44, v44, v8
    v_mul_f32 v45, v45, v8
    v_mul_f32 v46, v46, v8
    v_mul_f32 v47, v47, v8
    v_mul_f32 v48, v48, v8
    v_mul_f32 v49, v49, v8
    v_mul_f32 v50, v50, v8
    v_mul_f32 v51, v51, v8
    v_mul_f32 v52, v52, v8
    v_mul_f32 v53, v53, v8
    v_mul_f32 v54, v54, v8
    v_mul_f32 v55, v55, v8
    v_mul_f32 v56, v56, v8
    v_mul_f32 v57, v57, v8
    v_mul_f32 v58, v58, v8
    v_mul_f32 v59, v59, v8
    v_mul_f32 v60, v60, v8
    v_mul_f32 v61, v61, v8
    v_mul_f32 v62, v62, v8
    v_mul_f32 v63, v63, v8
    v_mul_f32 v64, v64, v8
    v_mul_f32 v65, v65, v8
    v_mul_f32 v66, v66, v8
    v_mul_f32 v67, v67, v8
    v_mul_f32 v68, v68, v8
    v_mul_f32 v69, v69, v8
    v_mul_f32 v70, v70, v8
    v_mul_f32 v71, v71, v8
Lnors_37:
    s_waitcnt vmcnt(24)
    s_cmp_lt_u32 s85, 512
    s_cbranch_scc1 Lw_38
    s_waitcnt vmcnt(0)
Lw_38:
    v_perm_b32 v16, v188, v184, s58
    v_perm_b32 v17, v196, v192, s58
    s_nop 1
    v_mfma_f32_16x16x16_bf16 v[40:43], v[16:17], v[14:15], v[40:43]
    v_perm_b32 v18, v188, v184, s59
    v_perm_b32 v19, v196, v192, s59
    s_nop 1
    v_mfma_f32_16x16x16_bf16 v[44:47], v[18:19], v[14:15], v[44:47]
    v_perm_b32 v16, v189, v185, s58
    v_perm_b32 v17, v197, v193, s58
    s_nop 1
    v_mfma_f32_16x16x16_bf16 v[48:51], v[16:17], v[14:15], v[48:51]
    v_perm_b32 v18, v189, v185, s59
    v_perm_b32 v19, v197, v193, s59
    s_nop 1
    v_mfma_f32_16x16x16_bf16 v[52:55], v[18:19], v[14:15], v[52:55]
    v_perm_b32 v16, v190, v186, s58
    v_perm_b32 v17, v198, v194, s58
    s_nop 1
    v_mfma_f32_16x16x16_bf16 v[56:59], v[16:17], v[14:15], v[56:59]
    v_perm_b32 v18, v190, v186, s59
    v_perm_b32 v19, v198, v194, s59
    s_nop 1
    v_mfma_f32_16x16x16_bf16 v[60:63], v[18:19], v[14:15], v[60:63]
    v_perm_b32 v16, v191, v187, s58
    v_perm_b32 v17, v199, v195, s58
    s_nop 1
    v_mfma_f32_16x16x16_bf16 v[64:67], v[16:17], v[14:15], v[64:67]
    v_perm_b32 v18, v191, v187, s59
    v_perm_b32 v19, v199, v195, s59
    s_nop 1
    v_mfma_f32_16x16x16_bf16 v[68:71], v[18:19], v[14:15], v[68:71]
    s_waitcnt vmcnt(20)
    s_cmp_lt_u32 s85, 512
    s_cbranch_scc1 Lw_39
    s_waitcnt vmcnt(0)
Lw_39:
    v_mfma_f32_16x16x32_bf16 v[10:13], v[200:203], v[24:27], 0
    v_mfma_f32_16x16x32_bf16 v[10:13], v[204:207], v[28:31], v[10:13]
    v_mfma_f32_16x16x32_bf16 v[10:13], v[208:211], v[32:35], v[10:13]
    v_mfma_f32_16x16x32_bf16 v[10:13], v[212:215], v[36:39], v[10:13]
    s_nop 7
    v_cvt_pk_bf16_f32 v5, v10, v11
    v_cvt_pk_bf16_f32 v6, v12, v13
    v_lshlrev_b32 v10, 16, v5
    v_and_b32 v11, 0xffff0000, v5
    v_lshlrev_b32 v12, 16, v6
    v_and_b32 v13, 0xffff0000, v6
    v_mul_f32 v10, s70, v10
    v_mul_f32 v11, s70, v11
    v_mul_f32 v12, s70, v12
    v_mul_f32 v13, s70, v13
    v_cvt_pk_bf16_f32 v5, v10, v11
    v_cvt_pk_bf16_f32 v6, v12, v13
    v_lshlrev_b32 v10, 16, v5
    v_and_b32 v11, 0xffff0000, v5
    v_lshlrev_b32 v12, 16, v6
    v_and_b32 v13, 0xffff0000, v6
    v_max3_f32 v7, v10, v11, v12
    v_max3_f32 v7, v7, v13, v3
    v_mov_b32 v5, v7
    v_mov_b32 v6, v7
    s_nop 1
    v_permlane16_swap_b32 v5, v6
    s_nop 1
    v_max_f32 v7, v5, v6
    v_mov_b32 v5, v7
    v_mov_b32 v6, v7
    s_nop 1
    v_permlane32_swap_b32 v5, v6
    s_nop 1
    v_max_f32 v7, v5, v6
    v_sub_f32 v8, v3, v7
    v_mul_f32 v8, s69, v8
    v_exp_f32 v8, v8
    v_mov_b32 v3, v7
    v_mul_f32 v7, s69, v7
    v_fma_f32 v10, v10, s69, -v7
    v_fma_f32 v11, v11, s69, -v7
    v_fma_f32 v12, v12, s69, -v7
    v_fma_f32 v13, v13, s69, -v7
    v_exp_f32 v10, v10
    v_exp_f32 v11, v11
    v_exp_f32 v12, v12
    v_exp_f32 v13, v13
    v_mul_f32 v4, v4, v8
    v_add_f32 v5, v10, v11
    v_add_f32 v6, v12, v13
    v_cvt_pk_bf16_f32 v14, v10, v11
    v_cvt_pk_bf16_f32 v15, v12, v13
    v_add_f32 v4, v4, v5
    v_add_f32 v4, v4, v6
    v_cmp_neq_f32 vcc, 1.0, v8
    s_cbranch_vccz Lnors_40
    v_mul_f32 v40, v40, v8
    v_mul_f32 v41, v41, v8
    v_mul_f32 v42, v42, v8
    v_mul_f32 v43, v43, v8
    v_mul_f32 v44, v44, v8
    v_mul_f32 v45, v45, v8
    v_mul_f32 v46, v46, v8
    v_mul_f32 v47, v47, v8
    v_mul_f32 v48, v48, v8
    v_mul_f32 v49, v49, v8
    v_mul_f32 v50, v50, v8
    v_mul_f32 v51, v51, v8
    v_mul_f32 v52, v52, v8
    v_mul_f32 v53, v53, v8
    v_mul_f32 v54, v54, v8
    v_mul_f32 v55, v55, v8
    v_mul_f32 v56, v56, v8
    v_mul_f32 v57, v57, v8
    v_mul_f32 v58, v58, v8
    v_mul_f32 v59, v59, v8
    v_mul_f32 v60, v60, v8
    v_mul_f32 v61, v61, v8
    v_mul_f32 v62, v62, v8
    v_mul_f32 v63, v63, v8
    v_mul_f32 v64, v64, v8
    v_mul_f32 v65, v65, v8
    v_mul_f32 v66, v66, v8
    v_mul_f32 v67, v67, v8
    v_mul_f32 v68, v68, v8
    v_mul_f32 v69, v69, v8
    v_mul_f32 v70, v70, v8
    v_mul_f32 v71, v71, v8
Lnors_40:
    s_waitcnt vmcnt(16)
    s_cmp_lt_u32 s85, 512
    s_cbranch_scc1 Lw_41
    s_waitcnt vmcnt(0)
Lw_41:
    v_perm_b32 v16, v220, v216, s58
    v_perm_b32 v17, v228, v224, s58
    s_nop 1
    v_mfma_f32_16x16x16_bf16 v[40:43], v[16:17], v[14:15], v[40:43]
    v_perm_b32 v18, v220, v216, s59
    v_perm_b32 v19, v228, v224, s59
    s_nop 1
    v_mfma_f32_16x16x16_bf16 v[44:47], v[18:19], v[14:15], v[44:47]
    v_perm_b32 v16, v221, v217, s58
    v_perm_b32 v17, v229, v225, s58
    s_nop 1
    v_mfma_f32_16x16x16_bf16 v[48:51], v[16:17], v[14:15], v[48:51]
    v_perm_b32 v18, v221, v217, s59
    v_perm_b32 v19, v229, v225, s59
    s_nop 1
    v_mfma_f32_16x16x16_bf16 v[52:55], v[18:19], v[14:15], v[52:55]
    v_perm_b32 v16, v222, v218, s58
    v_perm_b32 v17, v230, v226, s58
    s_nop 1
    v_mfma_f32_16x16x16_bf16 v[56:59], v[16:17], v[14:15], v[56:59]
    v_perm_b32 v18, v222, v218, s59
    v_perm_b32 v19, v230, v226, s59
    s_nop 1
    v_mfma_f32_16x16x16_bf16 v[60:63], v[18:19], v[14:15], v[60:63]
    v_perm_b32 v16, v223, v219, s58
    v_perm_b32 v17, v231, v227, s58
    s_nop 1
    v_mfma_f32_16x16x16_bf16 v[64:67], v[16:17], v[14:15], v[64:67]
    v_perm_b32 v18, v223, v219, s59
    v_perm_b32 v19, v231, v227, s59
    s_nop 1
    v_mfma_f32_16x16x16_bf16 v[68:71], v[18:19], v[14:15], v[68:71]
    s_branch L_Aloop
L_Adone:
    s_setprio 3
    s_mov_b64 exec, s[72:73]
    s_nop 1
    ds_write_b128 v232, v[40:43] offset:41984
    ds_write_b128 v232, v[44:47] offset:42000
    ds_write_b128 v232, v[48:51] offset:42016
    ds_write_b128 v232, v[52:55] offset:42032
    ds_write_b128 v232, v[56:59] offset:42048
    ds_write_b128 v232, v[60:63] offset:42064
    ds_write_b128 v232, v[64:67] offset:42080
    ds_write_b128 v232, v[68:71] offset:42096
    s_mov_b64 exec, -1
    v_mov_b32 v5, v4
    v_mov_b32 v6, v4
    s_nop 1
    v_permlane16_swap_b32 v5, v6
    s_nop 1
    v_add_f32 v4, v5, v6
    v_mov_b32 v5, v4
    v_mov_b32 v6, v4
    s_nop 1
    v_permlane32_swap_b32 v5, v6
    s_nop 1
    v_add_f32 v4, v5, v6
    s_mov_b64 exec, s[72:73]
    ds_write2_b32 v233, v3, v4 offset0:0 offset1:1
    s_mov_b64 exec, 1
    ds_add_u32 v21, v22 offset:12
    s_mov_b64 exec, -1
Llw_42:
    ds_read_b32 v8, v21 offset:12
    s_waitcnt lgkmcnt(0)
    v_readfirstlane_b32 s60, v8
    s_cmp_ge_u32 s60, 4
    s_cbranch_scc1 Llwd_43
    s_branch Llw_42
Llwd_43:
    ds_read_b128 v[24:27], v235 offset:41728
    ds_read_b128 v[28:31], v235 offset:41744
    ds_read_b128 v[72:75], v234 offset:41984
    ds_read_b128 v[76:79], v234 offset:46208
    ds_read_b128 v[80:83], v234 offset:50432
    ds_read_b128 v[84:87], v234 offset:54656
    s_waitcnt lgkmcnt(4)
    v_max3_f32 v10, v24, v26, v28
    v_max_f32 v10, v10, v30
    v_sub_f32 v24, v24, v10
    v_sub_f32 v26, v26, v10
    v_sub_f32 v28, v28, v10
    v_sub_f32 v30, v30, v10
    v_mul_f32 v24, s69, v24
    v_mul_f32 v26, s69, v26
    v_mul_f32 v28, s69, v28
    v_mul_f32 v30, s69, v30
    v_exp_f32 v24, v24
    v_exp_f32 v26, v26
    v_exp_f32 v28, v28
    v_exp_f32 v30, v30
    s_nop 0
    v_mul_f32 v11, v24, v25
    v_fmac_f32 v11, v26, v27
    v_fmac_f32 v11, v28, v29
    v_fmac_f32 v11, v30, v31
    s_nop 0
    v_rcp_f32 v12, v11
    v_log_f32 v11, v11
    s_waitcnt lgkmcnt(0)
    v_fmac_f32 v11, s69, v10
    v_pk_mul_f32 v[40:41], v[72:73], v[24:25] op_sel_hi:[1,0]
    v_pk_mul_f32 v[42:43], v[74:75], v[24:25] op_sel_hi:[1,0]
    v_pk_fma_f32 v[40:41], v[76:77], v[26:27], v[40:41] op_sel_hi:[1,0,1]
    v_pk_fma_f32 v[42:43], v[78:79], v[26:27], v[42:43] op_sel_hi:[1,0,1]
    v_pk_fma_f32 v[40:41], v[80:81], v[28:29], v[40:41] op_sel_hi:[1,0,1]
    v_pk_fma_f32 v[42:43], v[82:83], v[28:29], v[42:43] op_sel_hi:[1,0,1]
    v_pk_fma_f32 v[40:41], v[84:85], v[30:31], v[40:41] op_sel_hi:[1,0,1]
    v_pk_fma_f32 v[42:43], v[86:87], v[30:31], v[42:43] op_sel_hi:[1,0,1]
    v_pk_mul_f32 v[40:41], v[40:41], v[12:13] op_sel_hi:[1,0]
    v_pk_mul_f32 v[42:43], v[42:43], v[12:13] op_sel_hi:[1,0]
    v_perm_b32 v40, v40, v11, s74
    v_perm_b32 v41, v41, v11, s75
    v_perm_b32 v42, v42, v11, s76
    v_perm_b32 v43, v43, v11, s77
    v_min_u32 v40, -2, v40
    v_min_u32 v41, -2, v41
    v_min_u32 v42, -2, v42
    v_min_u32 v43, -2, v43
    buffer_store_dwordx4 v[40:43], v236, s[36:39], s71 offen sc1
L_Aexit:
    s_endpgm
L_blk9:
    s_branch L_blkret
L_G2:
    s_cmp_eq_u32 s89, 0
    s_cbranch_scc1 L_tailw
    s_mov_b32 s60, 0x3f803f80
    v_mov_b32 v236, 0
    v_mov_b32 v238, 0
    v_mov_b32 v240, 0
    v_mov_b32 v242, 0
    s_waitcnt vmcnt(40)
    s_cmp_eq_u32 s89, 2
    s_cbranch_scc1 Lrw_44
    s_waitcnt vmcnt(16)
Lrw_44:
    v_dot2c_f32_bf16 v236, s60, v10
    v_dot2c_f32_bf16 v240, v10, v10
    v_dot2c_f32_bf16 v238, s60, v18
    v_dot2c_f32_bf16 v242, v18, v18
    v_dot2c_f32_bf16 v236, s60, v11
    v_dot2c_f32_bf16 v240, v11, v11
    v_dot2c_f32_bf16 v238, s60, v19
    v_dot2c_f32_bf16 v242, v19, v19
    v_dot2c_f32_bf16 v236, s60, v12
    v_dot2c_f32_bf16 v240, v12, v12
    v_dot2c_f32_bf16 v238, s60, v20
    v_dot2c_f32_bf16 v242, v20, v20
    v_dot2c_f32_bf16 v236, s60, v13
    v_dot2c_f32_bf16 v240, v13, v13
    v_dot2c_f32_bf16 v238, s60, v21
    v_dot2c_f32_bf16 v242, v21, v21
    v_dot2c_f32_bf16 v236, s60, v14
    v_dot2c_f32_bf16 v240, v14, v14
    v_dot2c_f32_bf16 v238, s60, v22
    v_dot2c_f32_bf16 v242, v22, v22
    v_dot2c_f32_bf16 v236, s60, v15
    v_dot2c_f32_bf16 v240, v15, v15
    v_dot2c_f32_bf16 v238, s60, v23
    v_dot2c_f32_bf16 v242, v23, v23
    v_dot2c_f32_bf16 v236, s60, v16
    v_dot2c_f32_bf16 v240, v16, v16
    v_dot2c_f32_bf16 v238, s60, v24
    v_dot2c_f32_bf16 v242, v24, v24
    v_dot2c_f32_bf16 v236, s60, v17
    v_dot2c_f32_bf16 v240, v17, v17
    v_dot2c_f32_bf16 v238, s60, v25
    v_dot2c_f32_bf16 v242, v25, v25
    s_nop 2
    v_add_f32_dpp v236, v236, v236 quad_perm:[1,0,3,2] row_mask:0xf bank_mask:0xf
    v_add_f32_dpp v238, v238, v238 quad_perm:[1,0,3,2] row_mask:0xf bank_mask:0xf
    v_add_f32_dpp v240, v240, v240 quad_perm:[1,0,3,2] row_mask:0xf bank_mask:0xf
    v_add_f32_dpp v242, v242, v242 quad_perm:[1,0,3,2] row_mask:0xf bank_mask:0xf
    v_add_f32_dpp v236, v236, v236 quad_perm:[2,3,0,1] row_mask:0xf bank_mask:0xf
    v_add_f32_dpp v238, v238, v238 quad_perm:[2,3,0,1] row_mask:0xf bank_mask:0xf
    v_add_f32_dpp v240, v240, v240 quad_perm:[2,3,0,1] row_mask:0xf bank_mask:0xf
    v_add_f32_dpp v242, v242, v242 quad_perm:[2,3,0,1] row_mask:0xf bank_mask:0xf
    v_add_f32_dpp v236, v236, v236 row_half_mirror row_mask:0xf bank_mask:0xf
    v_add_f32_dpp v238, v238, v238 row_half_mirror row_mask:0xf bank_mask:0xf
    v_add_f32_dpp v240, v240, v240 row_half_mirror row_mask:0xf bank_mask:0xf
    v_add_f32_dpp v242, v242, v242 row_half_mirror row_mask:0xf bank_mask:0xf
    v_add_f32_dpp v236, v236, v236 row_mirror row_mask:0xf bank_mask:0xf
    v_add_f32_dpp v238, v238, v238 row_mirror row_mask:0xf bank_mask:0xf
    v_add_f32_dpp v240, v240, v240 row_mirror row_mask:0xf bank_mask:0xf
    v_add_f32_dpp v242, v242, v242 row_mirror row_mask:0xf bank_mask:0xf
    v_mov_b32 v244, v236
    v_mov_b32 v245, v236
    v_mov_b32 v246, v238
    v_mov_b32 v247, v238
    v_mov_b32 v248, v240
    v_mov_b32 v249, v240
    v_mov_b32 v250, v242
    v_mov_b32 v251, v242
    s_nop 1
    v_permlane16_swap_b32 v244, v245
    v_permlane16_swap_b32 v246, v247
    v_permlane16_swap_b32 v248, v249
    v_permlane16_swap_b32 v250, v251
    s_nop 1
    v_add_f32 v236, v244, v245
    v_add_f32 v238, v246, v247
    v_add_f32 v240, v248, v249
    v_add_f32 v242, v250, v251
    v_mov_b32 v244, v236
    v_mov_b32 v245, v236
    v_mov_b32 v246, v238
    v_mov_b32 v247, v238
    v_mov_b32 v248, v240
    v_mov_b32 v249, v240
    v_mov_b32 v250, v242
    v_mov_b32 v251, v242
    s_nop 1
    v_permlane32_swap_b32 v244, v245
    v_permlane32_swap_b32 v246, v247
    v_permlane32_swap_b32 v248, v249
    v_permlane32_swap_b32 v250, v251
    s_nop 1
    v_add_f32 v236, v244, v245
    v_add_f32 v238, v246, v247
    v_add_f32 v240, v248, v249
    v_add_f32 v242, v250, v251
    v_mul_f32 v236, 0x3a800000, v236
    v_mul_f32 v240, 0x3a800000, v240
    v_mul_f32 v238, 0x3a800000, v238
    v_mul_f32 v242, 0x3a800000, v242
    v_fma_f32 v240, -v236, v236, v240
    v_max_f32 v240, 0, v240
    v_fma_f32 v242, -v238, v238, v242
    v_max_f32 v242, 0, v242
    v_cvt_pk_bf16_f32 v244, v240, v240
    v_lshlrev_b32 v240, 16, v244
    v_cvt_pk_bf16_f32 v245, v242, v242
    v_lshlrev_b32 v242, 16, v245
    v_add_f32 v240, 0x3727c5ac, v240
    v_add_f32 v242, 0x3727c5ac, v242
    v_cvt_pk_bf16_f32 v244, v240, v240
    v_lshlrev_b32 v240, 16, v244
    v_cvt_pk_bf16_f32 v245, v242, v242
    v_lshlrev_b32 v242, 16, v245
    v_sqrt_f32 v240, v240
    v_sqrt_f32 v242, v242
    v_cvt_pk_bf16_f32 v246, v236, v236
    v_lshlrev_b32 v236, 16, v246
    v_cvt_pk_bf16_f32 v247, v238, v238
    v_lshlrev_b32 v238, 16, v247
    v_cvt_pk_bf16_f32 v244, v240, v240
    v_lshlrev_b32 v240, 16, v244
    v_cvt_pk_bf16_f32 v245, v242, v242
    v_lshlrev_b32 v242, 16, v245
    v_rcp_f32 v240, v240
    v_rcp_f32 v242, v242
    s_mul_i32 s60, s3, 4160
    v_add_u32 v2, s60, v1
    v_lshlrev_b32 v244, 16, v10
    v_and_b32 v245, 0xffff0000, v10
    v_pk_add_f32 v[244:245], v[244:245], v[236:237] op_sel_hi:[1,0] neg_lo:[0,1] neg_hi:[0,1]
    v_cvt_pk_bf16_f32 v248, v244, v245
    v_lshlrev_b32 v244, 16, v248
    v_and_b32 v245, 0xffff0000, v248
    v_pk_mul_f32 v[244:245], v[244:245], v[240:241] op_sel_hi:[1,0]
    v_cvt_pk_bf16_f32 v10, v244, v245
    v_lshlrev_b32 v246, 16, v11
    v_and_b32 v247, 0xffff0000, v11
    v_pk_add_f32 v[246:247], v[246:247], v[236:237] op_sel_hi:[1,0] neg_lo:[0,1] neg_hi:[0,1]
    v_cvt_pk_bf16_f32 v249, v246, v247
    v_lshlrev_b32 v246, 16, v249
    v_and_b32 v247, 0xffff0000, v249
    v_pk_mul_f32 v[246:247], v[246:247], v[240:241] op_sel_hi:[1,0]
    v_cvt_pk_bf16_f32 v11, v246, v247
    v_lshlrev_b32 v244, 16, v12
    v_and_b32 v245, 0xffff0000, v12
    v_pk_add_f32 v[244:245], v[244:245], v[236:237] op_sel_hi:[1,0] neg_lo:[0,1] neg_hi:[0,1]
    v_cvt_pk_bf16_f32 v248, v244, v245
    v_lshlrev_b32 v244, 16, v248
    v_and_b32 v245, 0xffff0000, v248
    v_pk_mul_f32 v[244:245], v[244:245], v[240:241] op_sel_hi:[1,0]
    v_cvt_pk_bf16_f32 v12, v244, v245
    v_lshlrev_b32 v246, 16, v13
    v_and_b32 v247, 0xffff0000, v13
    v_pk_add_f32 v[246:247], v[246:247], v[236:237] op_sel_hi:[1,0] neg_lo:[0,1] neg_hi:[0,1]
    v_cvt_pk_bf16_f32 v249, v246, v247
    v_lshlrev_b32 v246, 16, v249
    v_and_b32 v247, 0xffff0000, v249
    v_pk_mul_f32 v[246:247], v[246:247], v[240:241] op_sel_hi:[1,0]
    v_cvt_pk_bf16_f32 v13, v246, v247
    ds_write_b128 v2, v[10:13] offset:2304
    v_lshlrev_b32 v244, 16, v14
    v_and_b32 v245, 0xffff0000, v14
    v_pk_add_f32 v[244:245], v[244:245], v[236:237] op_sel_hi:[1,0] neg_lo:[0,1] neg_hi:[0,1]
    v_cvt_pk_bf16_f32 v248, v244, v245
    v_lshlrev_b32 v244, 16, v248
    v_and_b32 v245, 0xffff0000, v248
    v_pk_mul_f32 v[244:245], v[244:245], v[240:241] op_sel_hi:[1,0]
    v_cvt_pk_bf16_f32 v14, v244, v245
    v_lshlrev_b32 v246, 16, v15
    v_and_b32 v247, 0xffff0000, v15
    v_pk_add_f32 v[246:247], v[246:247], v[236:237] op_sel_hi:[1,0] neg_lo:[0,1] neg_hi:[0,1]
    v_cvt_pk_bf16_f32 v249, v246, v247
    v_lshlrev_b32 v246, 16, v249
    v_and_b32 v247, 0xffff0000, v249
    v_pk_mul_f32 v[246:247], v[246:247], v[240:241] op_sel_hi:[1,0]
    v_cvt_pk_bf16_f32 v15, v246, v247
    v_lshlrev_b32 v244, 16, v16
    v_and_b32 v245, 0xffff0000, v16
    v_pk_add_f32 v[244:245], v[244:245], v[236:237] op_sel_hi:[1,0] neg_lo:[0,1] neg_hi:[0,1]
    v_cvt_pk_bf16_f32 v248, v244, v245
    v_lshlrev_b32 v244, 16, v248
    v_and_b32 v245, 0xffff0000, v248
    v_pk_mul_f32 v[244:245], v[244:245], v[240:241] op_sel_hi:[1,0]
    v_cvt_pk_bf16_f32 v16, v244, v245
    v_lshlrev_b32 v246, 16, v17
    v_and_b32 v247, 0xffff0000, v17
    v_pk_add_f32 v[246:247], v[246:247], v[236:237] op_sel_hi:[1,0] neg_lo:[0,1] neg_hi:[0,1]
    v_cvt_pk_bf16_f32 v249, v246, v247
    v_lshlrev_b32 v246, 16, v249
    v_and_b32 v247, 0xffff0000, v249
    v_pk_mul_f32 v[246:247], v[246:247], v[240:241] op_sel_hi:[1,0]
    v_cvt_pk_bf16_f32 v17, v246, v247
    ds_write_b128 v2, v[14:17] offset:2320
    v_lshlrev_b32 v244, 16, v18
    v_and_b32 v245, 0xffff0000, v18
    v_pk_add_f32 v[244:245], v[244:245], v[238:239] op_sel_hi:[1,0] neg_lo:[0,1] neg_hi:[0,1]
    v_cvt_pk_bf16_f32 v248, v244, v245
    v_lshlrev_b32 v244, 16, v248
    v_and_b32 v245, 0xffff0000, v248
    v_pk_mul_f32 v[244:245], v[244:245], v[242:243] op_sel_hi:[1,0]
    v_cvt_pk_bf16_f32 v18, v244, v245
    v_lshlrev_b32 v246, 16, v19
    v_and_b32 v247, 0xffff0000, v19
    v_pk_add_f32 v[246:247], v[246:247], v[238:239] op_sel_hi:[1,0] neg_lo:[0,1] neg_hi:[0,1]
    v_cvt_pk_bf16_f32 v249, v246, v247
    v_lshlrev_b32 v246, 16, v249
    v_and_b32 v247, 0xffff0000, v249
    v_pk_mul_f32 v[246:247], v[246:247], v[242:243] op_sel_hi:[1,0]
    v_cvt_pk_bf16_f32 v19, v246, v247
    v_lshlrev_b32 v244, 16, v20
    v_and_b32 v245, 0xffff0000, v20
    v_pk_add_f32 v[244:245], v[244:245], v[238:239] op_sel_hi:[1,0] neg_lo:[0,1] neg_hi:[0,1]
    v_cvt_pk_bf16_f32 v248, v244, v245
    v_lshlrev_b32 v244, 16, v248
    v_and_b32 v245, 0xffff0000, v248
    v_pk_mul_f32 v[244:245], v[244:245], v[242:243] op_sel_hi:[1,0]
    v_cvt_pk_bf16_f32 v20, v244, v245
    v_lshlrev_b32 v246, 16, v21
    v_and_b32 v247, 0xffff0000, v21
    v_pk_add_f32 v[246:247], v[246:247], v[238:239] op_sel_hi:[1,0] neg_lo:[0,1] neg_hi:[0,1]
    v_cvt_pk_bf16_f32 v249, v246, v247
    v_lshlrev_b32 v246, 16, v249
    v_and_b32 v247, 0xffff0000, v249
    v_pk_mul_f32 v[246:247], v[246:247], v[242:243] op_sel_hi:[1,0]
    v_cvt_pk_bf16_f32 v21, v246, v247
    ds_write_b128 v2, v[18:21] offset:4384
    v_lshlrev_b32 v244, 16, v22
    v_and_b32 v245, 0xffff0000, v22
    v_pk_add_f32 v[244:245], v[244:245], v[238:239] op_sel_hi:[1,0] neg_lo:[0,1] neg_hi:[0,1]
    v_cvt_pk_bf16_f32 v248, v244, v245
    v_lshlrev_b32 v244, 16, v248
    v_and_b32 v245, 0xffff0000, v248
    v_pk_mul_f32 v[244:245], v[244:245], v[242:243] op_sel_hi:[1,0]
    v_cvt_pk_bf16_f32 v22, v244, v245
    v_lshlrev_b32 v246, 16, v23
    v_and_b32 v247, 0xffff0000, v23
    v_pk_add_f32 v[246:247], v[246:247], v[238:239] op_sel_hi:[1,0] neg_lo:[0,1] neg_hi:[0,1]
    v_cvt_pk_bf16_f32 v249, v246, v247
    v_lshlrev_b32 v246, 16, v249
    v_and_b32 v247, 0xffff0000, v249
    v_pk_mul_f32 v[246:247], v[246:247], v[242:243] op_sel_hi:[1,0]
    v_cvt_pk_bf16_f32 v23, v246, v247
    v_lshlrev_b32 v244, 16, v24
    v_and_b32 v245, 0xffff0000, v24
    v_pk_add_f32 v[244:245], v[244:245], v[238:239] op_sel_hi:[1,0] neg_lo:[0,1] neg_hi:[0,1]
    v_cvt_pk_bf16_f32 v248, v244, v245
    v_lshlrev_b32 v244, 16, v248
    v_and_b32 v245, 0xffff0000, v248
    v_pk_mul_f32 v[244:245], v[244:245], v[242:243] op_sel_hi:[1,0]
    v_cvt_pk_bf16_f32 v24, v244, v245
    v_lshlrev_b32 v246, 16, v25
    v_and_b32 v247, 0xffff0000, v25
    v_pk_add_f32 v[246:247], v[246:247], v[238:239] op_sel_hi:[1,0] neg_lo:[0,1] neg_hi:[0,1]
    v_cvt_pk_bf16_f32 v249, v246, v247
    v_lshlrev_b32 v246, 16, v249
    v_and_b32 v247, 0xffff0000, v249
    v_pk_mul_f32 v[246:247], v[246:247], v[242:243] op_sel_hi:[1,0]
    v_cvt_pk_bf16_f32 v25, v246, v247
    ds_write_b128 v2, v[22:25] offset:4400
    s_waitcnt lgkmcnt(0)
    s_mov_b64 exec, 1
    v_mov_b32 v8, 1
    ds_add_u32 v7, v8 offset:0
    s_mov_b64 exec, -1
    v_and_b32 v3, 7, v0
    v_mul_u32_u24 v4, 2080, v3
    v_lshrrev_b32 v8, 3, v0
    v_lshl_add_u32 v4, v8, 4, v4
    s_lshl_b32 s60, s67, 1
    v_add_u32 v4, s60, v4
    v_mul_u32_u24 v2, 320, v5
    v_and_b32 v8, 1, v6
    v_lshl_add_u32 v2, v8, 7, v2
    s_mul_i32 s60, s3, 5120
    v_add_u32 v2, s60, v2
    s_mov_b32 s74, 0x00ff00ff
    s_mov_b32 s75, 0xff00ff00
    s_lshl_b32 s60, s3, 1
    v_add_u32 v8, s60, v8
    v_mul_u32_u24 v1, 320, v8
    v_lshrrev_b32 v3, 5, v0
    v_mul_u32_u24 v3, 2560, v3
    v_add_u32 v1, v1, v3
    v_lshrrev_b32 v3, 3, v5
    v_lshl_add_u32 v1, v3, 7, v1
    v_and_b32 v3, 1, v5
    v_lshl_add_u32 v1, v3, 6, v1
    v_bfe_u32 v3, v5, 1, 2
    v_lshl_add_u32 v1, v3, 2, v1
    v_add_u32 v1, 18944, v1
    v_lshlrev_b32 v36, 14, v8
    v_lshl_add_u32 v36, v5, 4, v36
    v_lshlrev_b32 v37, 5, v8
    v_lshrrev_b32 v3, 2, v5
    v_lshl_add_u32 v37, v3, 8, v37
    v_and_b32 v3, 3, v5
    v_lshl_add_u32 v37, v3, 3, v37
Llw_45:
    ds_read_b32 v8, v7 offset:0
    s_waitcnt lgkmcnt(0)
    v_readfirstlane_b32 s60, v8
    s_cmp_ge_u32 s60, 4
    s_cbranch_scc1 Llwd_46
    s_branch Llw_45
Llwd_46:
    ds_read_b128 v[10:13], v4 offset:2304
    ds_read_b128 v[14:17], v4 offset:2432
    ds_read_b128 v[18:21], v4 offset:2560
    ds_read_b128 v[22:25], v4 offset:2688
    s_waitcnt vmcnt(32) lgkmcnt(0)
    s_cmp_eq_u32 s89, 2
    s_cbranch_scc1 Lrw_47
    s_waitcnt vmcnt(8)
Lrw_47:
    v_perm_b32 v26, v44, v40, s58
    v_perm_b32 v27, v52, v48, s58
    v_perm_b32 v28, v60, v56, s58
    v_perm_b32 v29, v68, v64, s58
    s_nop 1
    v_mfma_f32_16x16x32_bf16 v[104:107], v[26:29], v[10:13], 0
    v_perm_b32 v30, v44, v40, s59
    v_perm_b32 v31, v52, v48, s59
    v_perm_b32 v32, v60, v56, s59
    v_perm_b32 v33, v68, v64, s59
    s_nop 1
    v_mfma_f32_16x16x32_bf16 v[108:111], v[30:33], v[10:13], 0
    v_perm_b32 v26, v45, v41, s58
    v_perm_b32 v27, v53, v49, s58
    v_perm_b32 v28, v61, v57, s58
    v_perm_b32 v29, v69, v65, s58
    s_nop 1
    v_mfma_f32_16x16x32_bf16 v[112:115], v[26:29], v[10:13], 0
    v_perm_b32 v30, v45, v41, s59
    v_perm_b32 v31, v53, v49, s59
    v_perm_b32 v32, v61, v57, s59
    v_perm_b32 v33, v69, v65, s59
    s_nop 1
    v_mfma_f32_16x16x32_bf16 v[116:119], v[30:33], v[10:13], 0
    v_perm_b32 v26, v46, v42, s58
    v_perm_b32 v27, v54, v50, s58
    v_perm_b32 v28, v62, v58, s58
    v_perm_b32 v29, v70, v66, s58
    s_nop 1
    v_mfma_f32_16x16x32_bf16 v[120:123], v[26:29], v[10:13], 0
    v_perm_b32 v30, v46, v42, s59
    v_perm_b32 v31, v54, v50, s59
    v_perm_b32 v32, v62, v58, s59
    v_perm_b32 v33, v70, v66, s59
    s_nop 1
    v_mfma_f32_16x16x32_bf16 v[124:127], v[30:33], v[10:13], 0
    v_perm_b32 v26, v47, v43, s58
    v_perm_b32 v27, v55, v51, s58
    v_perm_b32 v28, v63, v59, s58
    v_perm_b32 v29, v71, v67, s58
    s_nop 1
    v_mfma_f32_16x16x32_bf16 v[128:131], v[26:29], v[10:13], 0
    v_perm_b32 v30, v47, v43, s59
    v_perm_b32 v31, v55, v51, s59
    v_perm_b32 v32, v63, v59, s59
    v_perm_b32 v33, v71, v67, s59
    s_nop 1
    v_mfma_f32_16x16x32_bf16 v[132:135], v[30:33], v[10:13], 0
    s_waitcnt vmcnt(24) lgkmcnt(0)
    s_cmp_eq_u32 s89, 2
    s_cbranch_scc1 Lrw_48
    s_waitcnt vmcnt(0)
Lrw_48:
    v_perm_b32 v26, v76, v72, s58
    v_perm_b32 v27, v84, v80, s58
    v_perm_b32 v28, v92, v88, s58
    v_perm_b32 v29, v100, v96, s58
    s_nop 1
    v_mfma_f32_16x16x32_bf16 v[104:107], v[26:29], v[14:17], v[104:107]
    v_perm_b32 v30, v76, v72, s59
    v_perm_b32 v31, v84, v80, s59
    v_perm_b32 v32, v92, v88, s59
    v_perm_b32 v33, v100, v96, s59
    s_nop 1
    v_mfma_f32_16x16x32_bf16 v[108:111], v[30:33], v[14:17], v[108:111]
    v_perm_b32 v26, v77, v73, s58
    v_perm_b32 v27, v85, v81, s58
    v_perm_b32 v28, v93, v89, s58
    v_perm_b32 v29, v101, v97, s58
    s_nop 1
    v_mfma_f32_16x16x32_bf16 v[112:115], v[26:29], v[14:17], v[112:115]
    v_perm_b32 v30, v77, v73, s59
    v_perm_b32 v31, v85, v81, s59
    v_perm_b32 v32, v93, v89, s59
    v_perm_b32 v33, v101, v97, s59
    s_nop 1
    v_mfma_f32_16x16x32_bf16 v[116:119], v[30:33], v[14:17], v[116:119]
    v_perm_b32 v26, v78, v74, s58
    s_branch L_blks3
.p2align 12
L_blk3:
    s_branch L_blkret
L_blks3:
    v_perm_b32 v27, v86, v82, s58
    v_perm_b32 v28, v94, v90, s58
    v_perm_b32 v29, v102, v98, s58
    s_nop 1
    v_mfma_f32_16x16x32_bf16 v[120:123], v[26:29], v[14:17], v[120:123]
    v_perm_b32 v30, v78, v74, s59
    v_perm_b32 v31, v86, v82, s59
    v_perm_b32 v32, v94, v90, s59
    v_perm_b32 v33, v102, v98, s59
    s_nop 1
    v_mfma_f32_16x16x32_bf16 v[124:127], v[30:33], v[14:17], v[124:127]
    v_perm_b32 v26, v79, v75, s58
    v_perm_b32 v27, v87, v83, s58
    v_perm_b32 v28, v95, v91, s58
    v_perm_b32 v29, v103, v99, s58
    s_nop 1
    v_mfma_f32_16x16x32_bf16 v[128:131], v[26:29], v[14:17], v[128:131]
    v_perm_b32 v30, v79, v75, s59
    v_perm_b32 v31, v87, v83, s59
    v_perm_b32 v32, v95, v91, s59
    v_perm_b32 v33, v103, v99, s59
    s_nop 1
    v_mfma_f32_16x16x32_bf16 v[132:135], v[30:33], v[14:17], v[132:135]
    s_cmp_lg_u32 s89, 2
    s_cbranch_scc1 L_onep
    s_waitcnt vmcnt(16) lgkmcnt(0)
    v_perm_b32 v26, v140, v136, s58
    v_perm_b32 v27, v148, v144, s58
    v_perm_b32 v28, v156, v152, s58
    v_perm_b32 v29, v164, v160, s58
    s_nop 1
    v_mfma_f32_16x16x32_bf16 v[104:107], v[26:29], v[18:21], v[104:107]
    v_perm_b32 v30, v140, v136, s59
    v_perm_b32 v31, v148, v144, s59
    v_perm_b32 v32, v156, v152, s59
    v_perm_b32 v33, v164, v160, s59
    s_nop 1
    v_mfma_f32_16x16x32_bf16 v[108:111], v[30:33], v[18:21], v[108:111]
    v_perm_b32 v26, v141, v137, s58
    v_perm_b32 v27, v149, v145, s58
    v_perm_b32 v28, v157, v153, s58
    v_perm_b32 v29, v165, v161, s58
    s_nop 1
    v_mfma_f32_16x16x32_bf16 v[112:115], v[26:29], v[18:21], v[112:115]
    v_perm_b32 v30, v141, v137, s59
    v_perm_b32 v31, v149, v145, s59
    v_perm_b32 v32, v157, v153, s59
    v_perm_b32 v33, v165, v161, s59
    s_nop 1
    v_mfma_f32_16x16x32_bf16 v[116:119], v[30:33], v[18:21], v[116:119]
    v_perm_b32 v26, v142, v138, s58
    v_perm_b32 v27, v150, v146, s58
    v_perm_b32 v28, v158, v154, s58
    v_perm_b32 v29, v166, v162, s58
    s_nop 1
    v_mfma_f32_16x16x32_bf16 v[120:123], v[26:29], v[18:21], v[120:123]
    v_perm_b32 v30, v142, v138, s59
    v_perm_b32 v31, v150, v146, s59
    v_perm_b32 v32, v158, v154, s59
    v_perm_b32 v33, v166, v162, s59
    s_nop 1
    v_mfma_f32_16x16x32_bf16 v[124:127], v[30:33], v[18:21], v[124:127]
    v_perm_b32 v26, v143, v139, s58
    v_perm_b32 v27, v151, v147, s58
    v_perm_b32 v28, v159, v155, s58
    v_perm_b32 v29, v167, v163, s58
    s_nop 1
    v_mfma_f32_16x16x32_bf16 v[128:131], v[26:29], v[18:21], v[128:131]
    v_perm_b32 v30, v143, v139, s59
    v_perm_b32 v31, v151, v147, s59
    v_perm_b32 v32, v159, v155, s59
    v_perm_b32 v33, v167, v163, s59
    s_nop 1
    v_mfma_f32_16x16x32_bf16 v[132:135], v[30:33], v[18:21], v[132:135]
    s_waitcnt vmcnt(8) lgkmcnt(0)
    v_perm_b32 v26, v204, v200, s58
    v_perm_b32 v27, v212, v208, s58
    v_perm_b32 v28, v220, v216, s58
    v_perm_b32 v29, v228, v224, s58
    s_nop 1
    v_mfma_f32_16x16x32_bf16 v[104:107], v[26:29], v[22:25], v[104:107]
    v_perm_b32 v30, v204, v200, s59
    v_perm_b32 v31, v212, v208, s59
    v_perm_b32 v32, v220, v216, s59
    v_perm_b32 v33, v228, v224, s59
    s_nop 1
    v_mfma_f32_16x16x32_bf16 v[108:111], v[30:33], v[22:25], v[108:111]
    v_perm_b32 v26, v205, v201, s58
    v_perm_b32 v27, v213, v209, s58
    v_perm_b32 v28, v221, v217, s58
    v_perm_b32 v29, v229, v225, s58
    s_nop 1
    v_mfma_f32_16x16x32_bf16 v[112:115], v[26:29], v[22:25], v[112:115]
    v_perm_b32 v30, v205, v201, s59
    v_perm_b32 v31, v213, v209, s59
    v_perm_b32 v32, v221, v217, s59
    v_perm_b32 v33, v229, v225, s59
    s_nop 1
    v_mfma_f32_16x16x32_bf16 v[116:119], v[30:33], v[22:25], v[116:119]
    v_perm_b32 v26, v206, v202, s58
    v_perm_b32 v27, v214, v210, s58
    v_perm_b32 v28, v222, v218, s58
    v_perm_b32 v29, v230, v226, s58
    s_nop 1
    v_mfma_f32_16x16x32_bf16 v[120:123], v[26:29], v[22:25], v[120:123]
    v_perm_b32 v30, v206, v202, s59
    v_perm_b32 v31, v214, v210, s59
    v_perm_b32 v32, v222, v218, s59
    v_perm_b32 v33, v230, v226, s59
    s_nop 1
    v_mfma_f32_16x16x32_bf16 v[124:127], v[30:33], v[22:25], v[124:127]
    v_perm_b32 v26, v207, v203, s58
    v_perm_b32 v27, v215, v211, s58
    v_perm_b32 v28, v223, v219, s58
    v_perm_b32 v29, v231, v227, s58
    s_nop 1
    v_mfma_f32_16x16x32_bf16 v[128:131], v[26:29], v[22:25], v[128:131]
    v_perm_b32 v30, v207, v203, s59
    v_perm_b32 v31, v215, v211, s59
    v_perm_b32 v32, v223, v219, s59
    v_perm_b32 v33, v231, v227, s59
    s_nop 1
    v_mfma_f32_16x16x32_bf16 v[132:135], v[30:33], v[22:25], v[132:135]
L_onep:
    s_nop 7
    s_mov_b64 exec, s[74:75]
    ds_write_b128 v2, v[104:107] offset:18944
    ds_write_b128 v2, v[108:111] offset:18960
    ds_write_b128 v2, v[112:115] offset:18976
    ds_write_b128 v2, v[116:119] offset:18992
    ds_write_b128 v2, v[120:123] offset:19008
    ds_write_b128 v2, v[124:127] offset:19024
    ds_write_b128 v2, v[128:131] offset:19040
    ds_write_b128 v2, v[132:135] offset:19056
    s_mov_b64 exec, -1
    s_waitcnt lgkmcnt(0)
    s_mov_b64 exec, 1
    v_mov_b32 v8, 1
    ds_add_u32 v7, v8 offset:4
    s_mov_b64 exec, -1
    s_cmp_lg_u32 s89, 2
    s_cbranch_scc1 L_notw
    s_cmp_eq_u32 s3, 3
    s_cselect_b32 s77, 0, -1
    s_mov_b32 s76, -1
    s_and_b32 s78, s56, 7
    s_lshr_b32 s79, s56, 3
    s_lshl_b32 s80, s78, 11
    s_lshl_b32 s60, s57, 8
    s_xor_b32 s60, s60, 1024
    s_add_u32 s80, s80, s60
    s_lshl_b32 s60, s79, 6
    s_add_u32 s80, s80, s60
    v_and_b32 v234, 7, v0
    v_lshlrev_b32 v234, 1, v234
    v_lshl_add_u32 v234, v6, 4, v234
    buffer_load_ushort v38, v234, s[32:35], s80 offen
L_notw:
Llw_49:
    ds_read_b32 v8, v7 offset:4
    s_waitcnt lgkmcnt(0)
    v_readfirstlane_b32 s60, v8
    s_cmp_ge_u32 s60, 4
    s_cbranch_scc1 Llwd_50
    s_branch Llw_49
Llwd_50:
    v_add_u32 v8, 0, v1
    ds_read2_b32 v[40:41], v8 offset0:0 offset1:4
    ds_read2_b32 v[42:43], v8 offset0:8 offset1:12
    v_add_u32 v8, 5120, v1
    ds_read2_b32 v[44:45], v8 offset0:0 offset1:4
    ds_read2_b32 v[46:47], v8 offset0:8 offset1:12
    v_add_u32 v8, 10240, v1
    ds_read2_b32 v[48:49], v8 offset0:0 offset1:4
    ds_read2_b32 v[50:51], v8 offset0:8 offset1:12
    v_add_u32 v8, 15360, v1
    ds_read2_b32 v[52:53], v8 offset0:0 offset1:4
    ds_read2_b32 v[54:55], v8 offset0:8 offset1:12
Llw_51:
    ds_read_b32 v8, v7 offset:28
    s_waitcnt lgkmcnt(0)
    v_readfirstlane_b32 s60, v8
    s_cmp_ge_u32 s60, 1
    s_cbranch_scc1 Llwd_52
    s_branch Llw_51
Llwd_52:
    v_add_f32 v40, v40, v44
    v_add_f32 v48, v48, v52
    v_add_f32 v41, v41, v45
    v_add_f32 v49, v49, v53
    v_add_f32 v42, v42, v46
    v_add_f32 v50, v50, v54
    v_add_f32 v43, v43, v47
    v_add_f32 v51, v51, v55
    v_add_f32 v40, v40, v48
    v_add_f32 v41, v41, v49
    v_add_f32 v42, v42, v50
    v_add_f32 v43, v43, v51
    v_mov_b32 v44, v40
    v_mov_b32 v45, v41
    v_mov_b32 v46, v42
    v_mov_b32 v47, v43
    s_nop 0
    v_permlane32_swap_b32 v40, v44
    v_permlane32_swap_b32 v41, v45
    v_permlane32_swap_b32 v42, v46
    v_permlane32_swap_b32 v43, v47
    s_nop 0
    v_add_f32 v40, v40, v44
    v_add_f32 v41, v41, v45
    v_add_f32 v42, v42, v46
    v_add_f32 v43, v43, v47
    s_mov_b32 exec_lo, -1
    s_mov_b32 exec_hi, 0
    s_cmp_eq_u32 s89, 2
    s_cbranch_scc1 L_pubf
    v_min_u32 v40, -2, v40
    v_min_u32 v41, -2, v41
    v_min_u32 v42, -2, v42
    v_min_u32 v43, -2, v43
    buffer_store_dwordx4 v[40:43], v36, s[36:39], s93 offen sc1
    s_mov_b64 exec, -1
    s_branch L_tailw
L_pubf:
    v_cvt_pk_bf16_f32 v40, v40, v41
    v_cvt_pk_bf16_f32 v41, v42, v43
    v_min_u32 v40, -2, v40
    v_min_u32 v41, -2, v41
    buffer_store_dwordx2 v[40:41], v37, s[36:39], s93 offen sc1
    s_mov_b64 exec, -1
    s_branch L_twd
L_tailw:
    s_cmp_eq_u32 s3, 3
    s_cselect_b32 s77, 0, -1
    s_mov_b32 s76, -1
    s_mov_b32 s44, s20
    s_mov_b32 s45, s21
    s_mov_b32 s46, 7340032
    s_mov_b32 s47, 0x00020000
    v_mov_b32 v168, 0
    v_mov_b32 v169, 0
    v_mov_b32 v170, 0
    v_mov_b32 v171, 0
    v_mov_b32 v172, 0
    v_mov_b32 v173, 0
    v_mov_b32 v174, 0
    v_mov_b32 v175, 0
    v_mov_b32 v176, 0
    v_mov_b32 v177, 0
    v_mov_b32 v178, 0
    v_mov_b32 v179, 0
    v_mov_b32 v180, 0
    v_mov_b32 v181, 0
    v_mov_b32 v182, 0
    v_mov_b32 v183, 0
    v_mov_b32 v184, 0
    v_mov_b32 v185, 0
    v_mov_b32 v186, 0
    v_mov_b32 v187, 0
    v_mov_b32 v188, 0
    v_mov_b32 v189, 0
    v_mov_b32 v190, 0
    v_mov_b32 v191, 0
    v_mov_b32 v192, 0
    v_mov_b32 v193, 0
    v_mov_b32 v194, 0
    v_mov_b32 v195, 0
    v_mov_b32 v196, 0
    v_mov_b32 v197, 0
    v_mov_b32 v198, 0
    v_mov_b32 v199, 0
    v_lshlrev_b32 v232, 14, v6
    v_lshl_add_u32 v232, v5, 4, v232
    s_mul_i32 s60, s56, 112
    s_lshl_b32 s61, s3, 5
    s_add_u32 s60, s60, s61
    s_lshl_b32 s60, s60, 11
    s_lshl_b32 s61, s57, 8
    s_add_u32 s52, s60, s61
    s_mov_b64 exec, s[76:77]
    buffer_load_dwordx4 v[168:171], v232, s[44:47], s52 offen offset:0 nt
    buffer_load_dwordx4 v[172:175], v232, s[44:47], s52 offen offset:2048 nt
    s_add_u32 s52, s52, 4096
    buffer_load_dwordx4 v[176:179], v232, s[44:47], s52 offen offset:0 nt
    buffer_load_dwordx4 v[180:183], v232, s[44:47], s52 offen offset:2048 nt
    s_add_u32 s52, s52, 4096
    buffer_load_dwordx4 v[184:187], v232, s[44:47], s52 offen offset:0 nt
    buffer_load_dwordx4 v[188:191], v232, s[44:47], s52 offen offset:2048 nt
    s_add_u32 s52, s52, 4096
    buffer_load_dwordx4 v[192:195], v232, s[44:47], s52 offen offset:0 nt
    buffer_load_dwordx4 v[196:199], v232, s[44:47], s52 offen offset:2048 nt
    s_add_u32 s52, s52, 4096
    s_mov_b64 exec, -1
    s_and_b32 s78, s56, 7
    s_lshr_b32 s79, s56, 3
    s_lshl_b32 s80, s78, 11
    s_lshl_b32 s60, s57, 8
    s_xor_b32 s60, s60, 1024
    s_add_u32 s80, s80, s60
    s_lshl_b32 s60, s79, 6
    s_add_u32 s80, s80, s60
    v_and_b32 v234, 7, v0
    v_lshlrev_b32 v234, 1, v234
    v_lshl_add_u32 v234, v6, 4, v234
    buffer_load_ushort v38, v234, s[32:35], s80 offen
L_twd:
    s_lshl_b32 s72, s2, 8
    s_add_u32 s72, s72, 1638400
    s_waitcnt vmcnt(0)
    s_mov_b32 s40, s12
    s_mov_b32 s41, s13
    s_mov_b32 s42, 8388608
    s_mov_b32 s43, 0x00020000
    v_lshlrev_b32 v233, 12, v6
    v_lshl_add_u32 v233, v5, 4, v233
    s_lshl_b32 s61, s57, 8
    s_lshl_b32 s60, s56, 2
    s_add_u32 s60, s60, s3
    s_lshl_b32 s60, s60, 16
    s_add_u32 s53, s60, s61
    s_mov_b64 s[74:75], -1
    s_sub_u32 s73, s95, 8
    s_cmp_lg_u32 s3, 0
    s_cbranch_scc1 L_nored
    s_sub_u32 s63, s95, 16
Llw_53:
    ds_read_b32 v8, v7 offset:20
    s_waitcnt lgkmcnt(0)
    v_readfirstlane_b32 s60, v8
    s_cmp_ge_u32 s60, s63
    s_cbranch_scc1 Llwd_54
    s_sleep 8
    s_branch Llw_53
Llwd_54:
    s_mov_b32 s61, 0
    s_mov_b64 exec, 1
Lmb_55:
    buffer_load_dword v28, v7, s[36:39], s72 offen offset:4 sc1
    s_add_u32 s61, s61, 1
    s_waitcnt vmcnt(0)
    v_cmp_ne_u32 vcc, 1, v28
    s_cmp_ge_u32 s61, s62
    s_cbranch_scc1 Lmbd_56
    s_cbranch_vccz Lmbd_56
    s_sleep 8
    s_branch Lmb_55
Lmbd_56:
    s_mov_b64 exec, -1
    s_waitcnt lgkmcnt(0)
    s_mov_b64 exec, 1
    v_mov_b32 v8, 1
    ds_add_u32 v7, v8 offset:24
    s_mov_b64 exec, -1
L_nored:
    v_mov_b32 v34, 0
    v_mov_b32 v35, 0
    v_mov_b32 v36, 0
    v_mov_b32 v37, 0
    v_and_b32 v2, 7, v0
    v_lshlrev_b32 v1, 5, v2
    v_and_b32 v3, 1, v6
    v_lshl_add_u32 v1, v3, 4, v1
    v_lshrrev_b32 v3, 5, v0
    v_lshl_add_u32 v1, v3, 8, v1
    v_lshrrev_b32 v3, 3, v5
    v_lshl_add_u32 v1, v3, 16, v1
    s_mul_i32 s81, s56, 7
    s_lshl_b32 s60, s3, 1
    s_add_u32 s81, s81, s60
    s_lshl_b32 s81, s81, 8
    s_add_u32 s81, s81, 524288
    s_cmp_lg_u32 s3, 1
    s_cbranch_scc1 L_nobrk
    v_mov_b32 v34, -1
    v_mov_b32 v35, -1
    v_mov_b32 v36, -1
    v_mov_b32 v37, -1
    s_and_b32 s82, s2, 0xf8
    s_lshl_b32 s82, s82, 8
    s_add_u32 s82, s82, 1638528
    s_sub_u32 s83, s95, 4
    s_mov_b32 s84, 0
    v_lshlrev_b32 v17, 2, v0
Llw_57:
    ds_read_b32 v8, v7 offset:8
    s_waitcnt lgkmcnt(0)
    v_readfirstlane_b32 s60, v8
    s_cmp_ge_u32 s60, 1
    s_cbranch_scc1 Llwd_58
    s_sleep 8
    s_branch Llw_57
Llwd_58:
    s_mov_b32 s88, 0
Lbw_59:
    ds_read2_b32 v[14:15], v7 offset0:5 offset1:6
    s_waitcnt lgkmcnt(0)
    v_readfirstlane_b32 s60, v14
    v_readfirstlane_b32 s61, v15
    s_cmp_ge_u32 s60, s83
    s_cbranch_scc1 Lbd_60
    s_sleep 2
    s_branch Lbw_59
Lbd_60:
    s_cmp_lt_u32 s60, s73
    s_cbranch_scc1 Lbnh_61
    s_cmp_le_u32 s61, s84
    s_cbranch_scc1 Lbnh_61
    buffer_load_dwordx4 v[34:37], v1, s[36:39], s81 offen sc1
    s_mov_b32 s84, 1
Lbnh_61:
    s_mov_b32 s85, 4
    s_add_u32 s83, s83, s85
    v_mov_b32 v10, s85
    s_mov_b64 exec, 1
    buffer_atomic_add v10, v7, s[36:39], s82 offen sc0
    s_mov_b64 exec, -1
L_brkl:
Lbw_62:
    ds_read2_b32 v[14:15], v7 offset0:5 offset1:6
    s_waitcnt lgkmcnt(0)
    v_readfirstlane_b32 s60, v14
    v_readfirstlane_b32 s61, v15
    s_cmp_ge_u32 s60, s83
    s_cbranch_scc1 Lbd_63
    s_sleep 2
    s_branch Lbw_62
Lbd_63:
    s_cmp_lt_u32 s60, s73
    s_cbranch_scc1 Lbnh_64
    s_cmp_le_u32 s61, s84
    s_cbranch_scc1 Lbnh_64
    buffer_load_dwordx4 v[34:37], v1, s[36:39], s81 offen sc1
    s_mov_b32 s84, 1
Lbnh_64:
    s_mov_b32 s86, 4
    s_add_u32 s83, s83, s86
    v_mov_b32 v11, s86
    s_mov_b64 exec, 1
    buffer_atomic_add v11, v7, s[36:39], s82 offen sc0
    s_mov_b64 exec, -1
    s_waitcnt vmcnt(1)
    v_readfirstlane_b32 s88, v10
    s_min_u32 s88, s88, 512
    s_add_u32 s88, s88, s94
    v_add_u32 v16, s88, v0
    s_add_u32 s60, s88, s85
    s_cmp_ge_u32 s60, 512
    s_cbranch_scc1 L_brke
    s_bfm_b64 exec, s85, 0
    ds_write_b32 v17, v16 offset:256
    s_mov_b64 exec, -1
    s_lshl_b32 s60, s85, 2
    v_add_u32 v17, s60, v17
Lbw_65:
    ds_read2_b32 v[14:15], v7 offset0:5 offset1:6
    s_waitcnt lgkmcnt(0)
    v_readfirstlane_b32 s60, v14
    v_readfirstlane_b32 s61, v15
    s_cmp_ge_u32 s60, s83
    s_cbranch_scc1 Lbd_66
    s_sleep 2
    s_branch Lbw_65
Lbd_66:
    s_cmp_lt_u32 s60, s73
    s_cbranch_scc1 Lbnh_67
    s_cmp_le_u32 s61, s84
    s_cbranch_scc1 Lbnh_67
    buffer_load_dwordx4 v[34:37], v1, s[36:39], s81 offen sc1
    s_mov_b32 s84, 1
Lbnh_67:
    s_mov_b32 s85, 4
    s_add_u32 s83, s83, s85
    v_mov_b32 v10, s85
    s_mov_b64 exec, 1
    buffer_atomic_add v10, v7, s[36:39], s82 offen sc0
    s_mov_b64 exec, -1
    s_waitcnt vmcnt(1)
    v_readfirstlane_b32 s88, v11
    s_min_u32 s88, s88, 512
    s_add_u32 s88, s88, s94
    v_add_u32 v16, s88, v0
    s_add_u32 s60, s88, s86
    s_cmp_ge_u32 s60, 512
    s_cbranch_scc1 L_brke
    s_bfm_b64 exec, s86, 0
    ds_write_b32 v17, v16 offset:256
    s_mov_b64 exec, -1
    s_lshl_b32 s60, s86, 2
    v_add_u32 v17, s60, v17
    s_branch L_brkl
L_brke:
    v_mov_b32 v18, 0x7fff
    v_cmp_lt_u32 vcc, 511, v16
    s_nop 1
    v_cndmask_b32 v16, v16, v18, vcc
    s_mov_b32 exec_lo, -1
    s_mov_b32 exec_hi, 0
    ds_write_b32 v17, v16 offset:256
    v_readfirstlane_b32 s60, v17
    s_min_u32 s88, s88, 512
    s_lshr_b32 s60, s60, 2
    s_add_u32 s60, s60, s95
    s_sub_u32 s60, s60, s88
    s_add_u32 s60, s60, 519
    v_mov_b32 v18, s60
    s_mov_b64 exec, 1
    ds_write_b32 v7, v18 offset:48
    s_mov_b64 exec, -1
    s_waitcnt vmcnt(0)
    v_max3_u32 v8, v34, v35, v36
    v_max_u32 v8, v8, v37
    v_cmp_eq_u32 vcc, -1, v8
    s_cbranch_vccz L_hok
L_nobrk:
Llw_68:
    ds_read_b32 v8, v7 offset:20
    s_waitcnt lgkmcnt(0)
    v_readfirstlane_b32 s60, v8
    s_cmp_ge_u32 s60, s73
    s_cbranch_scc1 Llwd_69
    s_sleep 8
    s_branch Llw_68
Llwd_69:
Llw_70:
    ds_read_b32 v8, v7 offset:24
    s_waitcnt lgkmcnt(0)
    v_readfirstlane_b32 s60, v8
    s_cmp_ge_u32 s60, 1
    s_cbranch_scc1 Llwd_71
    s_sleep 8
    s_branch Llw_70
Llwd_71:
    s_mov_b64 exec, s[76:77]
    s_mov_b32 s61, 0
    s_branch Lpollf_74
Lpoll_72:
    s_sleep 16
Lpollf_74:
    buffer_load_dwordx4 v[34:37], v1, s[36:39], s81 offen sc1
    s_waitcnt vmcnt(0)
    v_max3_u32 v8, v34, v35, v36
    v_max_u32 v8, v8, v37
    v_cmp_eq_u32 vcc, -1, v8
    s_add_u32 s61, s61, 1
    s_cmp_ge_u32 s61, s62
    s_cbranch_scc1 Lpolld_73
    s_and_b64 exec, exec, vcc
    s_cbranch_scc1 Lpoll_72
Lpolld_73:
    s_mov_b64 exec, -1
L_hok:
    v_mov_b32 v10, v34
    v_mov_b32 v12, v36
    v_mov_b32 v11, v35
    v_mov_b32 v13, v37
    v_mov_b32_dpp v10, v36 row_ror:8 row_mask:0xf bank_mask:0xc
    v_mov_b32_dpp v12, v34 row_ror:8 row_mask:0xf bank_mask:0x3
    v_mov_b32_dpp v11, v37 row_ror:8 row_mask:0xf bank_mask:0xc
    v_mov_b32_dpp v13, v35 row_ror:8 row_mask:0xf bank_mask:0x3
    s_mov_b32 s60, 0x3d372713
    s_mov_b32 s61, 0xc0135761
    v_lshlrev_b32 v14, 16, v10
    v_and_b32 v15, 0xffff0000, v10
    v_lshlrev_b32 v18, 16, v12
    v_and_b32 v19, 0xffff0000, v12
    v_lshlrev_b32 v16, 16, v11
    v_and_b32 v17, 0xffff0000, v11
    v_lshlrev_b32 v20, 16, v13
    v_and_b32 v21, 0xffff0000, v13
    v_mul_f32 v22, v14, v14
    v_mul_f32 v23, v15, v15
    v_mul_f32 v24, v16, v16
    v_mul_f32 v25, v17, v17
    v_mul_f32 v22, s60, v22
    v_mul_f32 v23, s60, v23
    v_mul_f32 v24, s60, v24
    v_mul_f32 v25, s60, v25
    v_fma_f32 v22, v22, v14, v14
    v_fma_f32 v23, v23, v15, v15
    v_fma_f32 v24, v24, v16, v16
    v_fma_f32 v25, v25, v17, v17
    v_mul_f32 v22, s61, v22
    v_mul_f32 v23, s61, v23
    v_mul_f32 v24, s61, v24
    v_mul_f32 v25, s61, v25
    v_exp_f32 v22, v22
    v_exp_f32 v23, v23
    v_exp_f32 v24, v24
    v_exp_f32 v25, v25
    s_nop 0
    v_add_f32 v22, 1.0, v22
    v_add_f32 v23, 1.0, v23
    v_add_f32 v24, 1.0, v24
    v_add_f32 v25, 1.0, v25
    v_rcp_f32 v22, v22
    v_rcp_f32 v23, v23
    v_rcp_f32 v24, v24
    v_rcp_f32 v25, v25
    s_nop 0
    v_mul_f32 v14, v14, v22
    v_mul_f32 v15, v15, v23
    v_mul_f32 v16, v16, v24
    v_mul_f32 v17, v17, v25
    v_cvt_pk_bf16_f32 v22, v14, v15
    v_cvt_pk_bf16_f32 v23, v16, v17
    v_lshlrev_b32 v14, 16, v22
    v_and_b32 v15, 0xffff0000, v22
    v_lshlrev_b32 v16, 16, v23
    v_and_b32 v17, 0xffff0000, v23
    v_mul_f32 v14, v14, v18
    v_mul_f32 v15, v15, v19
    v_mul_f32 v16, v16, v20
    v_mul_f32 v17, v17, v21
    v_cvt_pk_bf16_f32 v34, v14, v15
    v_cvt_pk_bf16_f32 v35, v16, v17
    s_nop 1
    v_mov_b32_dpp v36, v34 row_ror:8 row_mask:0xf bank_mask:0xf
    v_mov_b32_dpp v37, v35 row_ror:8 row_mask:0xf bank_mask:0xf
    v_perm_b32 v10, v172, v168, s58
    v_perm_b32 v11, v180, v176, s58
    v_perm_b32 v12, v188, v184, s58
    v_perm_b32 v13, v196, v192, s58
    s_nop 1
    v_mfma_f32_16x16x32_bf16 v[136:139], v[10:13], v[34:37], 0
    v_perm_b32 v14, v172, v168, s59
    v_perm_b32 v15, v180, v176, s59
    v_perm_b32 v16, v188, v184, s59
    v_perm_b32 v17, v196, v192, s59
    s_nop 1
    v_mfma_f32_16x16x32_bf16 v[140:143], v[14:17], v[34:37], 0
    v_perm_b32 v10, v173, v169, s58
    v_perm_b32 v11, v181, v177, s58
    v_perm_b32 v12, v189, v185, s58
    v_perm_b32 v13, v197, v193, s58
    s_nop 1
    v_mfma_f32_16x16x32_bf16 v[144:147], v[10:13], v[34:37], 0
    v_perm_b32 v14, v173, v169, s59
    v_perm_b32 v15, v181, v177, s59
    v_perm_b32 v16, v189, v185, s59
    v_perm_b32 v17, v197, v193, s59
    s_nop 1
    v_mfma_f32_16x16x32_bf16 v[148:151], v[14:17], v[34:37], 0
    v_perm_b32 v10, v174, v170, s58
    v_perm_b32 v11, v182, v178, s58
    v_perm_b32 v12, v190, v186, s58
    v_perm_b32 v13, v198, v194, s58
    s_nop 1
    v_mfma_f32_16x16x32_bf16 v[152:155], v[10:13], v[34:37], 0
    v_perm_b32 v14, v174, v170, s59
    v_perm_b32 v15, v182, v178, s59
    v_perm_b32 v16, v190, v186, s59
    v_perm_b32 v17, v198, v194, s59
    s_nop 1
    v_mfma_f32_16x16x32_bf16 v[156:159], v[14:17], v[34:37], 0
    v_perm_b32 v10, v175, v171, s58
    v_perm_b32 v11, v183, v179, s58
    v_perm_b32 v12, v191, v187, s58
    v_perm_b32 v13, v199, v195, s58
    s_nop 1
    v_mfma_f32_16x16x32_bf16 v[160:163], v[10:13], v[34:37], 0
    v_perm_b32 v14, v175, v171, s59
    v_perm_b32 v15, v183, v179, s59
    v_perm_b32 v16, v191, v187, s59
    v_perm_b32 v17, v199, v195, s59
    s_nop 1
    v_mfma_f32_16x16x32_bf16 v[164:167], v[14:17], v[34:37], 0
    v_lshrrev_b32 v3, 3, v0
    v_lshlrev_b32 v4, 17, v2
    v_lshl_add_u32 v4, v3, 4, v4
    s_lshl_b32 s60, s79, 15
    s_lshl_b32 s61, s78, 9
    s_add_u32 s60, s60, s61
    s_lshl_b32 s61, s3, 7
    s_add_u32 s60, s60, s61
    s_add_u32 s81, s60, 2097152
    s_add_u32 s82, s81, 4096
    s_add_u32 s83, s81, 8192
    s_add_u32 s84, s81, 12288
    s_add_u32 s85, s81, 16384
    s_add_u32 s86, s81, 20480
    s_add_u32 s87, s81, 24576
    s_add_u32 s88, s81, 28672
    s_mov_b64 s[4:5], -1
    s_mov_b64 s[6:7], -1
    s_mov_b64 s[8:9], -1
    s_mov_b64 s[10:11], -1
    s_mov_b64 s[12:13], -1
    s_mov_b64 s[14:15], -1
    s_mov_b64 s[16:17], -1
    s_mov_b64 s[18:19], -1
    s_mov_b32 s70, 0x0c0c0400
    s_mov_b32 s71, 0x05040100
    v_mov_b32 v231, -1
Llw_75:
    ds_read_b32 v8, v7 offset:48
    s_waitcnt lgkmcnt(0)
    v_readfirstlane_b32 s60, v8
    s_cmp_ge_u32 s60, 1
    s_cbranch_scc1 Llwd_76
    s_sleep 4
    s_branch Llw_75
Llwd_76:
    s_mov_b32 s63, s60
Llw_77:
    ds_read_b32 v8, v7 offset:20
    s_waitcnt lgkmcnt(0)
    v_readfirstlane_b32 s60, v8
    s_cmp_ge_u32 s60, s63
    s_cbranch_scc1 Llwd_78
    s_sleep 2
    s_branch Llw_77
Llwd_78:
    s_mov_b32 s61, 0
    buffer_load_dwordx4 v[200:203], v233, s[40:43], s53 offen offset:0 nt
    buffer_load_dwordx4 v[216:219], v233, s[40:43], s53 offen offset:2048 nt
    s_add_u32 s53, s53, 16384
    buffer_load_dwordx4 v[204:207], v233, s[40:43], s53 offen offset:0 nt
    buffer_load_dwordx4 v[220:223], v233, s[40:43], s53 offen offset:2048 nt
    s_add_u32 s53, s53, 16384
    buffer_load_dwordx4 v[208:211], v233, s[40:43], s53 offen offset:0 nt
    buffer_load_dwordx4 v[224:227], v233, s[40:43], s53 offen offset:2048 nt
    s_add_u32 s53, s53, 16384
    buffer_load_dwordx4 v[212:215], v233, s[40:43], s53 offen offset:0 nt
    buffer_load_dwordx4 v[228:231], v233, s[40:43], s53 offen offset:2048 nt
    s_add_u32 s53, s53, 16384
    s_waitcnt vmcnt(0)
    v_perm_b32 v104, v204, v200, s58
    v_perm_b32 v105, v212, v208, s58
    v_perm_b32 v106, v220, v216, s58
    v_perm_b32 v107, v228, v224, s58
    v_perm_b32 v108, v204, v200, s59
    v_perm_b32 v109, v212, v208, s59
    v_perm_b32 v110, v220, v216, s59
    v_perm_b32 v111, v228, v224, s59
    v_perm_b32 v112, v205, v201, s58
    v_perm_b32 v113, v213, v209, s58
    v_perm_b32 v114, v221, v217, s58
    v_perm_b32 v115, v229, v225, s58
    v_perm_b32 v116, v205, v201, s59
    v_perm_b32 v117, v213, v209, s59
    v_perm_b32 v118, v221, v217, s59
    v_perm_b32 v119, v229, v225, s59
    v_perm_b32 v120, v206, v202, s58
    v_perm_b32 v121, v214, v210, s58
    v_perm_b32 v122, v222, v218, s58
    v_perm_b32 v123, v230, v226, s58
    v_perm_b32 v124, v206, v202, s59
    v_perm_b32 v125, v214, v210, s59
    v_perm_b32 v126, v222, v218, s59
    v_perm_b32 v127, v230, v226, s59
    v_perm_b32 v128, v207, v203, s58
    v_perm_b32 v129, v215, v211, s58
    v_perm_b32 v130, v223, v219, s58
    v_perm_b32 v131, v231, v227, s58
    v_perm_b32 v132, v207, v203, s59
    v_perm_b32 v133, v215, v211, s59
    v_perm_b32 v134, v223, v219, s59
    s_branch L_blks4
.p2align 12
L_blk4:
    s_branch L_blkret
L_blks4:
    v_perm_b32 v135, v231, v227, s59
Llw_79:
    ds_read_b32 v8, v7 offset:12
    s_waitcnt lgkmcnt(0)
    v_readfirstlane_b32 s60, v8
    s_cmp_ge_u32 s60, 4
    s_cbranch_scc1 Llwd_80
    s_sleep 4
    s_branch Llw_79
Llwd_80:
    s_branch L_h1f
L_h1l:
    s_cmp_le_u32 s60, 64
    s_cbranch_scc1 L_h1f
    s_sleep 8
L_h1f:
    s_mov_b64 exec, s[4:5]
    s_cbranch_execz Lh1s_81
    buffer_load_dwordx4 v[72:75], v4, s[36:39], s81 offen sc1
Lh1s_81:
    s_mov_b64 exec, s[6:7]
    s_cbranch_execz Lh1s_82
    buffer_load_dwordx4 v[76:79], v4, s[36:39], s82 offen sc1
Lh1s_82:
    s_mov_b64 exec, s[8:9]
    s_cbranch_execz Lh1s_83
    buffer_load_dwordx4 v[80:83], v4, s[36:39], s83 offen sc1
Lh1s_83:
    s_mov_b64 exec, s[10:11]
    s_cbranch_execz Lh1s_84
    buffer_load_dwordx4 v[84:87], v4, s[36:39], s84 offen sc1
Lh1s_84:
    s_mov_b64 exec, s[12:13]
    s_cbranch_execz Lh1s_85
    buffer_load_dwordx4 v[88:91], v4, s[36:39], s85 offen sc1
Lh1s_85:
    s_mov_b64 exec, s[14:15]
    s_cbranch_execz Lh1s_86
    buffer_load_dwordx4 v[92:95], v4, s[36:39], s86 offen sc1
Lh1s_86:
    s_mov_b64 exec, s[16:17]
    s_cbranch_execz Lh1s_87
    buffer_load_dwordx4 v[96:99], v4, s[36:39], s87 offen sc1
Lh1s_87:
    s_mov_b64 exec, s[18:19]
    s_cbranch_execz Lh1s_88
    buffer_load_dwordx4 v[100:103], v4, s[36:39], s88 offen sc1
Lh1s_88:
    s_mov_b64 exec, -1
    s_add_u32 s61, s61, 1
L_h1w:
    s_waitcnt vmcnt(0)
    v_max3_u32 v24, v72, v73, v74
    v_max3_u32 v25, v76, v77, v78
    v_max3_u32 v26, v80, v81, v82
    v_max3_u32 v27, v84, v85, v86
    v_max3_u32 v28, v88, v89, v90
    v_max3_u32 v29, v92, v93, v94
    v_max3_u32 v30, v96, v97, v98
    v_max3_u32 v31, v100, v101, v102
    v_max_u32 v24, v24, v75
    v_max_u32 v25, v25, v79
    v_max_u32 v26, v26, v83
    v_max_u32 v27, v27, v87
    v_max_u32 v28, v28, v91
    v_max_u32 v29, v29, v95
    v_max_u32 v30, v30, v99
    v_max_u32 v31, v31, v103
    v_max3_u32 v10, v24, v25, v26
    v_max3_u32 v11, v27, v28, v29
    v_max3_u32 v10, v10, v30, v31
    v_max_u32 v10, v10, v11
    v_cmp_eq_u32 vcc, -1, v10
    s_cmp_ge_u32 s61, s62
    s_cbranch_scc1 L_h1d
    s_cbranch_vccz L_h1d
    v_cmp_eq_u32 s[4:5], -1, v24
    v_cmp_eq_u32 s[6:7], -1, v25
    v_cmp_eq_u32 s[8:9], -1, v26
    v_cmp_eq_u32 s[10:11], -1, v27
    v_cmp_eq_u32 s[12:13], -1, v28
    v_cmp_eq_u32 s[14:15], -1, v29
    v_cmp_eq_u32 s[16:17], -1, v30
    v_cmp_eq_u32 s[18:19], -1, v31
    s_mov_b32 s60, 0
    s_nop 2
    s_bcnt1_i32_b64 s63, s[4:5]
    s_add_u32 s60, s60, s63
    s_bcnt1_i32_b64 s63, s[6:7]
    s_add_u32 s60, s60, s63
    s_bcnt1_i32_b64 s63, s[8:9]
    s_add_u32 s60, s60, s63
    s_bcnt1_i32_b64 s63, s[10:11]
    s_add_u32 s60, s60, s63
    s_bcnt1_i32_b64 s63, s[12:13]
    s_add_u32 s60, s60, s63
    s_bcnt1_i32_b64 s63, s[14:15]
    s_add_u32 s60, s60, s63
    s_bcnt1_i32_b64 s63, s[16:17]
    s_add_u32 s60, s60, s63
    s_bcnt1_i32_b64 s63, s[18:19]
    s_add_u32 s60, s60, s63
    s_branch L_h1l
L_h1d:
L_dry:
    v_perm_b32 v24, v73, v72, s70
    v_perm_b32 v12, v75, v74, s70
    v_perm_b32 v25, v77, v76, s70
    v_perm_b32 v13, v79, v78, s70
    v_perm_b32 v26, v81, v80, s70
    v_perm_b32 v14, v83, v82, s70
    v_perm_b32 v27, v85, v84, s70
    v_perm_b32 v15, v87, v86, s70
    v_perm_b32 v28, v89, v88, s70
    v_perm_b32 v16, v91, v90, s70
    v_perm_b32 v29, v93, v92, s70
    v_perm_b32 v17, v95, v94, s70
    v_perm_b32 v30, v97, v96, s70
    v_perm_b32 v18, v99, v98, s70
    v_perm_b32 v31, v101, v100, s70
    v_perm_b32 v19, v103, v102, s70
    v_perm_b32 v24, v12, v24, s71
    v_perm_b32 v25, v13, v25, s71
    v_perm_b32 v26, v14, v26, s71
    v_perm_b32 v27, v15, v27, s71
    v_perm_b32 v28, v16, v28, s71
    v_perm_b32 v29, v17, v29, s71
    v_perm_b32 v30, v18, v30, s71
    v_perm_b32 v31, v19, v31, s71
    v_max3_f32 v10, v24, v25, v26
    v_max3_f32 v11, v27, v28, v29
    v_max3_f32 v10, v10, v30, v31
    v_max_f32 v10, v10, v11
    v_pk_add_f32 v[24:25], v[24:25], v[10:11] op_sel_hi:[1,0] neg_lo:[0,1] neg_hi:[0,1]
    v_pk_add_f32 v[26:27], v[26:27], v[10:11] op_sel_hi:[1,0] neg_lo:[0,1] neg_hi:[0,1]
    v_pk_add_f32 v[28:29], v[28:29], v[10:11] op_sel_hi:[1,0] neg_lo:[0,1] neg_hi:[0,1]
    v_pk_add_f32 v[30:31], v[30:31], v[10:11] op_sel_hi:[1,0] neg_lo:[0,1] neg_hi:[0,1]
    v_exp_f32 v24, v24
    v_exp_f32 v25, v25
    v_exp_f32 v26, v26
    v_exp_f32 v27, v27
    v_exp_f32 v28, v28
    v_exp_f32 v29, v29
    v_exp_f32 v30, v30
    v_exp_f32 v31, v31
    v_pk_mul_f32 v[16:17], v[72:73], v[24:25] op_sel_hi:[1,0]
    v_pk_mul_f32 v[18:19], v[74:75], v[24:25] op_sel_hi:[1,0]
    v_pk_add_f32 v[10:11], v[24:25], v[26:27]
    v_pk_add_f32 v[12:13], v[28:29], v[30:31]
    v_pk_add_f32 v[10:11], v[10:11], v[12:13]
    v_add_f32 v10, v10, v11
    v_pk_fma_f32 v[16:17], v[76:77], v[24:25], v[16:17] op_sel:[0,1,0] op_sel_hi:[1,1,1]
    v_pk_fma_f32 v[18:19], v[78:79], v[24:25], v[18:19] op_sel:[0,1,0] op_sel_hi:[1,1,1]
    v_rcp_f32 v10, v10
    v_pk_fma_f32 v[16:17], v[80:81], v[26:27], v[16:17] op_sel:[0,0,0] op_sel_hi:[1,0,1]
    v_pk_fma_f32 v[18:19], v[82:83], v[26:27], v[18:19] op_sel:[0,0,0] op_sel_hi:[1,0,1]
    v_pk_fma_f32 v[16:17], v[84:85], v[26:27], v[16:17] op_sel:[0,1,0] op_sel_hi:[1,1,1]
    v_pk_fma_f32 v[18:19], v[86:87], v[26:27], v[18:19] op_sel:[0,1,0] op_sel_hi:[1,1,1]
    v_pk_fma_f32 v[16:17], v[88:89], v[28:29], v[16:17] op_sel:[0,0,0] op_sel_hi:[1,0,1]
    v_pk_fma_f32 v[18:19], v[90:91], v[28:29], v[18:19] op_sel:[0,0,0] op_sel_hi:[1,0,1]
    v_pk_fma_f32 v[16:17], v[92:93], v[28:29], v[16:17] op_sel:[0,1,0] op_sel_hi:[1,1,1]
    v_pk_fma_f32 v[18:19], v[94:95], v[28:29], v[18:19] op_sel:[0,1,0] op_sel_hi:[1,1,1]
    v_pk_fma_f32 v[16:17], v[96:97], v[30:31], v[16:17] op_sel:[0,0,0] op_sel_hi:[1,0,1]
    v_pk_fma_f32 v[18:19], v[98:99], v[30:31], v[18:19] op_sel:[0,0,0] op_sel_hi:[1,0,1]
    v_pk_fma_f32 v[16:17], v[100:101], v[30:31], v[16:17] op_sel:[0,1,0] op_sel_hi:[1,1,1]
    v_pk_fma_f32 v[18:19], v[102:103], v[30:31], v[18:19] op_sel:[0,1,0] op_sel_hi:[1,1,1]
    v_pk_mul_f32 v[16:17], v[16:17], v[10:11] op_sel_hi:[1,0]
    v_pk_mul_f32 v[18:19], v[18:19], v[10:11] op_sel_hi:[1,0]
    v_cvt_pk_bf16_f32 v20, v16, v17
    v_cvt_pk_bf16_f32 v21, v18, v19
    s_nop 1
    v_mov_b32_dpp v22, v20 row_ror:8 row_mask:0xf bank_mask:0xf
    v_mov_b32_dpp v23, v21 row_ror:8 row_mask:0xf bank_mask:0xf
    s_nop 1
    v_mfma_f32_16x16x32_bf16 v[136:139], v[104:107], v[20:23], v[136:139]
    v_mfma_f32_16x16x32_bf16 v[140:143], v[108:111], v[20:23], v[140:143]
    v_mfma_f32_16x16x32_bf16 v[144:147], v[112:115], v[20:23], v[144:147]
    v_mfma_f32_16x16x32_bf16 v[148:151], v[116:119], v[20:23], v[148:151]
    v_mfma_f32_16x16x32_bf16 v[152:155], v[120:123], v[20:23], v[152:155]
    v_mfma_f32_16x16x32_bf16 v[156:159], v[124:127], v[20:23], v[156:159]
    v_mfma_f32_16x16x32_bf16 v[160:163], v[128:131], v[20:23], v[160:163]
    v_mfma_f32_16x16x32_bf16 v[164:167], v[132:135], v[20:23], v[164:167]
L_pub2:
    v_mul_u32_u24 v3, 528, v5
    v_lshl_add_u32 v3, v6, 7, v3
    s_mul_i32 s60, s3, 4224
    s_add_u32 s60, s60, 2304
    v_add_u32 v3, s60, v3
    v_cmp_gt_u32 vcc, 8, v5
    s_and_b64 exec, exec, vcc
    s_nop 4
    ds_write_b128 v3, v[136:139] offset:0
    ds_write_b128 v3, v[140:143] offset:16
    ds_write_b128 v3, v[144:147] offset:32
    ds_write_b128 v3, v[148:151] offset:48
    ds_write_b128 v3, v[152:155] offset:64
    ds_write_b128 v3, v[156:159] offset:80
    ds_write_b128 v3, v[160:163] offset:96
    ds_write_b128 v3, v[164:167] offset:112
    s_mov_b64 exec, -1
    v_lshrrev_b32 v3, 5, v0
    s_lshl_b32 s60, s3, 1
    v_add_u32 v3, s60, v3
    v_and_b32 v4, 31, v0
    v_mul_u32_u24 v8, 528, v3
    v_lshl_add_u32 v8, v4, 4, v8
    v_add_u32 v8, 2304, v8
    v_lshlrev_b32 v3, 9, v3
    v_lshl_add_u32 v3, v4, 4, v3
    s_lshl_b32 s61, s57, 5
    s_add_u32 s61, s61, s56
    s_lshl_b32 s61, s61, 12
    s_add_u32 s61, s61, 3145728
    s_waitcnt lgkmcnt(0)
    s_barrier
L_nobar:
    ds_read_b128 v[12:15], v8 offset:0
    ds_read_b128 v[16:19], v8 offset:4224
    ds_read_b128 v[20:23], v8 offset:8448
    ds_read_b128 v[24:27], v8 offset:12672
    s_waitcnt lgkmcnt(0)
    v_pk_add_f32 v[12:13], v[12:13], v[16:17]
    v_pk_add_f32 v[20:21], v[20:21], v[24:25]
    v_pk_add_f32 v[14:15], v[14:15], v[18:19]
    v_pk_add_f32 v[22:23], v[22:23], v[26:27]
    v_pk_add_f32 v[12:13], v[12:13], v[20:21]
    v_pk_add_f32 v[14:15], v[14:15], v[22:23]
    v_min_u32 v12, -2, v12
    v_min_u32 v13, -2, v13
    v_min_u32 v14, -2, v14
    v_min_u32 v15, -2, v15
    buffer_store_dwordx4 v[12:15], v3, s[36:39], s61 offen sc1
L_fin:
    s_cmp_lg_u32 s3, 0
    s_cbranch_scc1 L_Gexit
L_nofp:
    v_lshrrev_b32 v2, 3, v0
    v_and_b32 v3, 7, v0
    v_lshlrev_b32 v4, 14, v2
    v_lshl_add_u32 v4, v3, 4, v4
    s_lshl_b32 s60, s57, 17
    s_xor_b32 s60, s60, 524288
    s_lshl_b32 s61, s78, 9
    s_add_u32 s60, s60, s61
    s_lshl_b32 s61, s79, 7
    s_add_u32 s60, s60, s61
    s_add_u32 s81, s60, 3145728
    s_add_u32 s82, s81, 4096
    s_add_u32 s83, s81, 8192
    s_add_u32 s84, s81, 12288
    s_mov_b32 s48, s22
    s_mov_b32 s49, s23
    s_mov_b32 s50, 16384
    s_mov_b32 s51, 0x00020000
    v_lshlrev_b32 v38, 16, v38
    s_mov_b32 s64, 0x00ff00ff
    s_mov_b32 s65, 0x00ff00ff
    v_lshlrev_b32 v33, 1, v3
    v_lshl_add_u32 v33, v6, 4, v33
    s_mov_b64 exec, s[74:75]
    s_mov_b32 s61, 0
    s_branch Lpollf_91
Lpoll_89:
Lpollf_91:
    buffer_load_dwordx4 v[40:43], v4, s[36:39], s81 offen sc1
    buffer_load_dwordx4 v[44:47], v4, s[36:39], s82 offen sc1
    buffer_load_dwordx4 v[48:51], v4, s[36:39], s83 offen sc1
    buffer_load_dwordx4 v[52:55], v4, s[36:39], s84 offen sc1
    s_waitcnt vmcnt(0)
    v_max3_u32 v8, v40, v41, v42
    v_max3_u32 v8, v8, v43, v44
    v_max3_u32 v8, v8, v45, v46
    v_max3_u32 v8, v8, v47, v48
    v_max3_u32 v8, v8, v49, v50
    v_max3_u32 v8, v8, v51, v52
    v_max3_u32 v8, v8, v53, v54
    v_max_u32 v8, v8, v55
    v_cmp_eq_u32 vcc, -1, v8
    s_add_u32 s61, s61, 1
    s_cmp_ge_u32 s61, s62
    s_cbranch_scc1 Lpolld_90
    s_and_b64 exec, exec, vcc
    s_cbranch_scc1 Lpoll_89
Lpolld_90:
    s_mov_b64 exec, -1
    v_pk_add_f32 v[40:41], v[40:41], v[44:45]
    v_pk_add_f32 v[48:49], v[48:49], v[52:53]
    v_pk_add_f32 v[42:43], v[42:43], v[46:47]
    v_pk_add_f32 v[50:51], v[50:51], v[54:55]
    v_pk_add_f32 v[40:41], v[40:41], v[48:49]
    v_pk_add_f32 v[42:43], v[42:43], v[50:51]
    s_nop 0
    v_permlane32_swap_b32 v40, v42
    v_permlane32_swap_b32 v41, v43
    s_nop 0
    v_add_f32 v40, v40, v42
    v_add_f32 v41, v41, v43
    s_nop 1
    v_permlane16_swap_b32 v40, v41
    s_nop 1
    v_add_f32 v40, v40, v41
    v_add_f32 v41, v40, v38
    s_nop 0
    v_add_f32_dpp v40, v40, v41 row_ror:8 row_mask:0xf bank_mask:0xf
    v_cvt_pk_bf16_f32 v40, v40, v40
    s_mov_b64 exec, s[64:65]
    buffer_store_short v40, v33, s[48:51], s80 offen
    s_mov_b64 exec, -1
L_Gexit:
L_end:
    s_endpgm
.section .rodata,"a"
.p2align 6
.amdhsa_kernel parallel_sum__gqa_block_cached__glu_gated_geglu__decode_kernel
  .amdhsa_next_free_vgpr 256
  .amdhsa_next_free_sgpr 96
  .amdhsa_accum_offset 256
  .amdhsa_group_segment_fixed_size 0
  .amdhsa_kernarg_size 96
  .amdhsa_user_sgpr_count 2
  .amdhsa_user_sgpr_kernarg_segment_ptr 1
  .amdhsa_system_sgpr_workgroup_id_x 1
.end_amdhsa_kernel
```
